```python
import torch

def _softmax(x, axis=-1):
    return torch.softmax(x, dim=axis)
def _gelu(x):
    return torch.nn.functional.gelu(x, approximate="tanh")
def _silu(x):
    return torch.nn.functional.silu(x)
def _sigmoid(x):
    return torch.sigmoid(x)
def _layernorm(x, axis=-1, eps=1e-5):
    m = x.mean(dim=axis, keepdim=True)
    v = x.var(dim=axis, keepdim=True, unbiased=False)
    return (x - m) / torch.sqrt(v + eps)
def _scatter_add(tgt, idx, src, axis=0):
    return tgt.clone().index_add_(axis, idx, src)
def _segment_sum(src, seg, n):
    out = torch.zeros((n,) + src.shape[1:], dtype=src.dtype)
    return out.index_add_(0, seg, src)
def _pad(x, pw):
    flat = tuple(v for pair in reversed(pw) for v in pair)
    return torch.nn.functional.pad(x, flat)

kernel_name = 'parallel_sum__linear_attn_block__glu_gated_reglu__prompt'

def setup_inputs():

    _w = (lambda a: (lambda t: t.to(torch.bfloat16) if t.is_floating_point() else t)(torch.as_tensor(a)))
    def _A_setup():
        B, S, D = 1, 2048, 512
        return {
            "x": _w((lambda *s: torch.randn(*s, dtype=torch.bfloat16) * 0.05)(B, S, D)),
            "wqkv": _w((lambda *s: torch.randn(*s, dtype=torch.bfloat16) * 0.05)(D, 3 * D)),
            "wo": _w((lambda *s: torch.randn(*s, dtype=torch.bfloat16) * 0.05)(D, D)),
        }
    _A_in = _A_setup()

    def _B_setup():
        B, S, D, F = 1, 2048, 512, 1792
        return {
            "x": _w((lambda *s: torch.randn(*s, dtype=torch.bfloat16) * 0.05)(B, S, D)),
            "W_gate": _w((lambda *s: torch.randn(*s, dtype=torch.bfloat16) * 0.2)(D, F) * (2.0 / D) ** 0.5),
            "W_up": _w((lambda *s: torch.randn(*s, dtype=torch.bfloat16) * 0.2)(D, F) * (2.0 / D) ** 0.5),
            "W_down": _w((lambda *s: torch.randn(*s, dtype=torch.bfloat16) * 0.2)(F, D) * (1.0 / F) ** 0.5),
        }
    _B_in = _B_setup()

    return {
        "A_x": _A_in["x"],
        "A_wqkv": _A_in["wqkv"],
        "A_wo": _A_in["wo"],
        "B_x": _B_in["x"],
        "B_W_gate": _B_in["W_gate"],
        "B_W_up": _B_in["W_up"],
        "B_W_down": _B_in["W_down"],
    }

def reference(A_x, A_wqkv, A_wo, B_x, B_W_gate, B_W_up, B_W_down):
    def _A_ref(x, wqkv, wo):
        B, S, D = x.shape
        H = 32; Dh = D // H
        qkv = (lambda x, *d: x.permute(*d))((x @ wqkv).reshape(B, S, 3, H, Dh), 2, 0, 3, 1, 4)
        q, k, v = qkv[0], qkv[1], qkv[2]
        phi = lambda t: torch.where(t > 0, t + 1, torch.exp(t)) + 1e-6
        pq, pk = phi(q), phi(k)
        kv = torch.einsum("bhsd,bhse->bhde", pk, v)
        z = torch.einsum("bhsd->bhd", pk)
        num = torch.einsum("bhqd,bhde->bhqe", pq, kv)
        den = torch.einsum("bhqd,bhd->bhq", pq, z)[..., None] + 1e-6
        o = num / den
        return (lambda x, *d: x.permute(*d))(o, 0, 2, 1, 3).reshape(B, S, D) @ wo

    def _B_ref(x, W_gate, W_up, W_down):
        gate = torch.einsum("bsd,df->bsf", x, W_gate)
        up = torch.einsum("bsd,df->bsf", x, W_up)
        gate = gate * (lambda x, dt: x.to(dt))(gate > 0, gate.dtype)
        h = gate * up
        return torch.einsum("bsf,fd->bsd", h, W_down)

    x = A_x
    xn = _layernorm(x, axis=-1)
    return x + _A_ref(xn, A_wqkv, A_wo) + _B_ref(xn, B_W_gate, B_W_up, B_W_down)
```

```asm
; @launch grid=(256,1,1) block=(512,1,1) lds=163840
.amdgcn_target "amdgcn-amd-amdhsa--gfx950"
.text
.globl parallel_sum__linear_attn_block__glu_gated_reglu__prompt_kernel
.p2align 8
.type parallel_sum__linear_attn_block__glu_gated_reglu__prompt_kernel,@function
parallel_sum__linear_attn_block__glu_gated_reglu__prompt_kernel:
    s_cmp_ge_u32 s2, 256
    s_cbranch_scc1 Lend
    s_load_dwordx2 s[8:9], s[0:1], 0
    s_load_dwordx2 s[64:65], s[0:1], 8
    s_load_dwordx4 s[68:71], s[0:1], 32
    s_load_dwordx2 s[12:13], s[0:1], 72
    s_load_dwordx2 s[32:33], s[0:1], 48
    s_load_dwordx2 s[36:37], s[0:1], 16
    s_load_dwordx2 s[16:17], s[0:1], 56
    s_mov_b32 s10, 2097152
    s_mov_b32 s11, 0x00020000
    s_mov_b32 s14, 268435456
    s_mov_b32 s15, 0x00020000
    s_mov_b32 s18, 2097152
    s_mov_b32 s19, 0x00020000
    s_mov_b32 s34, 1835008
    s_mov_b32 s35, 0x00020000
    s_mov_b32 s38, 524288
    s_mov_b32 s39, 0x00020000
    s_mov_b32 s26, 1835008
    s_mov_b32 s27, 0x00020000
    s_mov_b32 s23, 0x00020000
    s_mov_b32 s31, 0x00020000
    v_and_b32 v1, 63, v0
    v_lshrrev_b32 v32, 6, v0
    v_lshlrev_b32 v2, 4, v1
    v_readfirstlane_b32 s72, v32
    s_nop 0
    s_and_b32 s46, s72, 3
    s_and_b32 s3, s2, 7
    s_lshr_b32 s45, s2, 3
    s_lshr_b32 s7, s3, 2
    s_lshl_b32 s47, s7, 3
    s_lshr_b32 s7, s45, 2
    s_add_u32 s47, s47, s7
    s_and_b32 s7, s3, 3
    s_lshl_b32 s48, s7, 2
    s_and_b32 s7, s45, 3
    s_add_u32 s48, s48, s7
    s_lshr_b32 s49, s48, 1
    s_and_b32 s50, s48, 1
    s_bfe_u32 s83, s3, 65537
    s_lshl_b32 s80, s47, 1
    s_add_u32 s80, s80, s83
    s_and_b32 s81, s3, 1
    s_lshl_b32 s81, s81, 2
    s_and_b32 s7, s45, 3
    s_add_u32 s81, s81, s7
    s_mov_b32 s82, s47
    s_lshl_b32 s51, s46, 12
    s_lshl_b32 s57, s46, 13
    s_cmp_lt_u32 s72, 4
    s_cbranch_scc1 Lcompute
    s_add_u32 s6, s48, s47
    s_and_b32 s4, s6, 3
    s_lshl_b32 s6, s47, 7
    s_lshl_b32 s7, s46, 5
    s_add_u32 s6, s6, s7
    s_lshl_b32 s56, s6, 10
    v_lshrrev_b32 v44, 3, v1
    v_and_b32 v45, 7, v1
    v_lshrrev_b32 v47, 4, v1
    v_xor_b32 v47, v45, v47
    v_lshlrev_b32 v47, 4, v47
    v_lshl_add_u32 v16, v44, 10, v47
    v_xor_b32 v47, 64, v16
    v_add_u32 v17, 7168, v47
    v_add_u32 v18, 14336, v16
    v_add_u32 v19, 21504, v47
    s_cmp_eq_u32 s50, 0
    s_movk_i32 s6, 3072
    s_movk_i32 s7, 3584
    s_cselect_b32 s42, s6, s7
    s_cselect_b32 s43, s7, s6
    s_mov_b32 s6, 1572864
    s_mov_b32 s7, 1835008
    s_cselect_b32 s22, s6, s7
    s_cselect_b32 s30, s7, s6
    v_bfe_u32 v43, v1, 4, 1
    v_lshlrev_b32 v46, 2, v43
    v_xor_b32 v46, v45, v46
    v_lshlrev_b32 v46, 4, v46
    v_mul_lo_u32 v47, v44, s42
    v_add_u32 v4, v47, v46
    s_lshl_b32 s6, s42, 3
    s_sub_u32 s6, s6, 1024
    v_add_u32 v5, s6, v4
    v_add_u32 v6, s6, v5
    v_add_u32 v7, s6, v6
    s_lshr_b32 s72, s46, 1
    s_lshl_b32 s73, s72, 10
    s_add_u32 s73, s73, 1024
    s_lshl_b32 s7, s49, 7
    s_add_u32 s73, s73, s7
    s_lshl_b32 s6, s49, 8
    s_add_u32 s6, s6, 1024
    s_cmp_eq_u32 s50, 0
    s_cselect_b32 s40, s73, s6
    s_and_b32 s73, s46, 1
    s_lshl_b32 s53, s42, 6
    s_mul_i32 s6, s73, s42
    s_lshl_b32 s7, s6, 5
    s_add_u32 s52, s40, s7
    s_waitcnt lgkmcnt(0)
    s_add_u32 m0, s51, 81920
    s_add_u32 s7, s4, 0
    s_and_b32 s7, s7, 3
    s_lshl_b32 s7, s7, 7
    s_add_u32 s58, s56, s7
    buffer_load_dwordx4 v16, s[8:11], s58 offen lds
    buffer_load_dwordx4 v17, s[8:11], s58 offen offset:1024 lds
    buffer_load_dwordx4 v18, s[8:11], s58 offen offset:2048 lds
    buffer_load_dwordx4 v19, s[8:11], s58 offen offset:3072 lds
    s_cmp_lt_u32 s46, 2
    s_cselect_b32 s24, s68, s70
    s_cselect_b32 s25, s69, s71
    s_cmp_eq_u32 s50, 0
    s_cselect_b32 s20, s64, s24
    s_cselect_b32 s21, s65, s25
    s_cselect_b32 s28, s24, s64
    s_cselect_b32 s29, s25, s65
    s_add_u32 m0, s51, 0
    s_add_u32 s7, s4, 0
    s_and_b32 s7, s7, 3
    s_mul_i32 s7, s7, s53
    s_add_u32 s59, s52, s7
    buffer_load_dwordx4 v4, s[20:23], s59 offen lds
    buffer_load_dwordx4 v5, s[20:23], s59 offen offset:1024 lds
    buffer_load_dwordx4 v6, s[20:23], s59 offen offset:2048 lds
    buffer_load_dwordx4 v7, s[20:23], s59 offen offset:3072 lds
    s_add_u32 m0, s51, 98304
    s_add_u32 s7, s4, 1
    s_and_b32 s7, s7, 3
    s_lshl_b32 s7, s7, 7
    s_add_u32 s58, s56, s7
    buffer_load_dwordx4 v16, s[8:11], s58 offen lds
    buffer_load_dwordx4 v17, s[8:11], s58 offen offset:1024 lds
    buffer_load_dwordx4 v18, s[8:11], s58 offen offset:2048 lds
    buffer_load_dwordx4 v19, s[8:11], s58 offen offset:3072 lds
    s_add_u32 m0, s51, 16384
    s_add_u32 s7, s4, 1
    s_and_b32 s7, s7, 3
    s_mul_i32 s7, s7, s53
    s_add_u32 s59, s52, s7
    buffer_load_dwordx4 v4, s[20:23], s59 offen lds
    buffer_load_dwordx4 v5, s[20:23], s59 offen offset:1024 lds
    buffer_load_dwordx4 v6, s[20:23], s59 offen offset:2048 lds
    buffer_load_dwordx4 v7, s[20:23], s59 offen offset:3072 lds
    s_load_dwordx2 s[60:61], s[12:13], 0
    v_lshrrev_b32 v40, 5, v1
    v_bfe_u32 v41, v1, 2, 2
    v_and_b32 v42, 3, v1
    s_lshl_b32 s7, s49, 7
    s_lshl_b32 s6, s49, 8
    s_add_u32 s6, s6, 1152
    s_cmp_eq_u32 s50, 0
    s_cselect_b32 s41, s7, s6
    s_lshr_b32 s6, s49, 1
    s_lshl_b32 s6, s6, 7
    s_add_u32 s6, s6, 3072
    s_and_b32 s73, s49, 1
    s_lshl_b32 s73, s73, 6
    s_add_u32 s6, s6, s73
    s_lshl_b32 s73, s72, 6
    s_add_u32 s73, s73, s7
    s_cmp_eq_u32 s50, 0
    s_cselect_b32 s44, s6, s73
    s_and_b32 s72, s46, 1
    s_and_b32 s6, s47, 7
    s_lshl_b32 s6, s6, 5
    s_and_b32 s7, s46, 1
    s_lshl_b32 s7, s7, 4
    s_add_u32 s6, s6, s7
    s_add_u32 s6, s6, 256
    v_and_b32 v50, 15, v1
    v_add_u32 v50, s6, v50
    v_mul_lo_u32 v51, v50, s42
    buffer_load_dword v28, v51, s[20:23], s40 offen
    v_and_b32 v52, 7, v1
    v_bfe_u32 v53, v1, 3, 2
    v_add_u32 v53, 4, v53
    v_lshlrev_b32 v52, 10, v52
    v_lshl_add_u32 v52, v53, 7, v52
    s_lshl_b32 s6, s47, 7
    s_and_b32 s7, s48, 3
    s_lshl_b32 s7, s7, 5
    s_add_u32 s6, s6, s7
    s_lshl_b32 s7, s46, 3
    s_add_u32 s6, s6, s7
    s_lshl_b32 s6, s6, 10
    buffer_load_dword v28, v52, s[8:11], s6 offen
    v_lshlrev_b32 v47, 5, v43
    v_lshl_add_u32 v47, v42, 3, v47
    v_lshl_add_u32 v48, v40, 3, v41
    v_lshlrev_b32 v48, 6, v48
    v_add_u32 v3, v48, v47
    v_lshlrev_b32 v24, 4, v40
    s_movk_i32 s7, 3584
    v_mul_lo_u32 v47, v44, s7
    v_add_u32 v8, v47, v46
    v_add_u32 v9, 27648, v8
    v_add_u32 v10, 27648, v9
    v_add_u32 v11, 27648, v10
    s_mul_i32 s7, s72, 114688
    s_add_u32 s54, s41, s7
    v_lshrrev_b32 v49, 2, v1
    v_mul_lo_u32 v47, v49, s43
    v_lshl_add_u32 v12, v42, 4, v47
    s_lshl_b32 s6, s43, 4
    s_sub_u32 s6, s6, 1024
    v_add_u32 v13, s6, v12
    v_add_u32 v14, s6, v13
    v_add_u32 v15, s6, v14
    s_lshl_b32 s55, s43, 6
    v_lshl_add_u32 v20, v44, 10, v46
    v_add_u32 v21, 7168, v20
    v_add_u32 v22, 14336, v20
    v_add_u32 v23, 21504, v20
    v_mul_lo_u32 v47, v49, s42
    v_lshl_add_u32 v34, v42, 4, v47
    s_lshl_b32 s6, s42, 4
    s_sub_u32 s6, s6, 1024
    v_add_u32 v35, s6, v34
    s_movk_i32 s7, 3584
    v_mul_lo_u32 v47, v49, s7
    v_lshl_add_u32 v36, v42, 4, v47
    v_add_u32 v37, 56320, v36
    s_and_b32 s6, s47, 7
    s_lshl_b32 s6, s6, 6
    s_lshr_b32 s7, s47, 3
    s_lshl_b32 s7, s7, 5
    s_add_u32 s6, s6, s7
    s_lshl_b32 s7, s72, 6
    s_mul_i32 s73, s6, s42
    s_add_u32 s73, s73, s40
    s_add_u32 s73, s73, s7
    s_mul_i32 s74, s6, 3584
    s_add_u32 s74, s74, s41
    s_add_u32 s74, s74, s7
    s_mul_i32 s75, s6, s43
    s_add_u32 s75, s75, s44
    s_lshl_b32 s62, s48, 13
    s_add_u32 s62, s62, 131072
    s_lshl_b32 s6, s47, 7
    s_lshl_b32 s7, s48, 3
    s_add_u32 s6, s6, s7
    s_lshl_b32 s7, s46, 1
    s_add_u32 s76, s6, s7
    v_and_b32 v25, 31, v1
    v_lshlrev_b32 v25, 2, v25
    v_add_u32 v25, 149504, v25
    v_cmp_eq_u32 vcc, 0, v1
    v_mov_b32 v26, 2147483632
    v_mov_b32 v47, 0
    v_cndmask_b32 v26, v26, v47, vcc
    s_lshl_b32 s6, s47, 1
    s_lshr_b32 s7, s46, 1
    s_add_u32 s6, s6, s7
    s_mul_i32 s6, s6, 768
    s_lshl_b32 s7, s48, 4
    s_add_u32 s6, s6, s7
    s_lshl_b32 s7, s72, 3
    s_add_u32 s6, s6, s7
    s_add_u32 s77, s6, 8192
    s_lshr_b32 s68, s45, 2
    s_add_u32 s68, s68, s81
    s_and_b32 s68, s68, 7
    s_lshl_b32 s69, s68, 1
    s_lshr_b32 s69, 9586980, s69
    s_and_b32 s69, s69, 3
    s_add_u32 s6, s68, 0
    s_and_b32 s6, s6, 1
    s_lshl_b32 s6, s6, 3
    s_lshl_b32 s7, s46, 1
    s_add_u32 s6, s6, s7
    s_add_u32 s6, s6, 8
    s_mov_b32 s5, s6
    s_add_u32 s6, s68, 1
    s_and_b32 s6, s6, 1
    s_lshl_b32 s6, s6, 3
    s_lshl_b32 s7, s46, 1
    s_add_u32 s6, s6, s7
    s_add_u32 s6, s6, 8
    s_lshl_b32 s6, s6, 8
    s_or_b32 s5, s5, s6
    s_add_u32 s6, s68, 0
    s_and_b32 s6, s6, 3
    s_lshl_b32 s6, s6, 2
    s_add_u32 s6, s6, s46
    s_lshl_b32 s7, s6, 1
    s_sub_u32 s7, s7, 7
    s_cmp_lt_u32 s6, 8
    s_cselect_b32 s6, s6, s7
    s_lshl_b32 s6, s6, 16
    s_or_b32 s5, s5, s6
    s_add_u32 s6, s68, 1
    s_and_b32 s6, s6, 3
    s_lshl_b32 s6, s6, 2
    s_add_u32 s6, s6, s46
    s_lshl_b32 s7, s6, 1
    s_sub_u32 s7, s7, 7
    s_cmp_lt_u32 s6, 8
    s_cselect_b32 s6, s6, s7
    s_lshl_b32 s6, s6, 24
    s_or_b32 s5, s5, s6
    s_add_u32 s6, s68, 2
    s_and_b32 s6, s6, 3
    s_lshl_b32 s6, s6, 2
    s_add_u32 s6, s6, s46
    s_lshl_b32 s7, s6, 1
    s_sub_u32 s7, s7, 7
    s_cmp_lt_u32 s6, 8
    s_cselect_b32 s6, s6, s7
    s_mov_b32 s3, s6
    s_add_u32 s6, s68, 3
    s_and_b32 s6, s6, 3
    s_lshl_b32 s6, s6, 2
    s_add_u32 s6, s6, s46
    s_lshl_b32 s7, s6, 1
    s_sub_u32 s7, s7, 7
    s_cmp_lt_u32 s6, 8
    s_cselect_b32 s6, s6, s7
    s_lshl_b32 s6, s6, 8
    s_or_b32 s3, s3, s6
    s_add_u32 s6, s69, 0
    s_sub_u32 s7, s6, 3
    s_cmp_lt_u32 s6, 3
    s_cselect_b32 s6, s6, s7
    s_lshl_b32 s6, s6, 2
    s_add_u32 s6, s6, s46
    s_add_u32 s6, s6, 24
    s_lshl_b32 s6, s6, 16
    s_or_b32 s3, s3, s6
    s_add_u32 s6, s69, 1
    s_sub_u32 s7, s6, 3
    s_cmp_lt_u32 s6, 3
    s_cselect_b32 s6, s6, s7
    s_lshl_b32 s6, s6, 2
    s_add_u32 s6, s6, s46
    s_add_u32 s6, s6, 24
    s_lshl_b32 s6, s6, 24
    s_or_b32 s3, s3, s6
    s_add_u32 s6, s69, 2
    s_sub_u32 s7, s6, 3
    s_cmp_lt_u32 s6, 3
    s_cselect_b32 s6, s6, s7
    s_lshl_b32 s6, s6, 2
    s_add_u32 s6, s6, s46
    s_add_u32 s6, s6, 24
    s_mov_b32 s63, s6
    s_waitcnt lgkmcnt(0)
    s_add_u32 s60, s60, 1
    s_addc_u32 s61, s61, 0
    v_mov_b32 v30, s60
    v_mov_b32 v31, s61
    s_cmp_eq_u32 s50, 0
    s_cbranch_scc0 Lhodd
    s_waitcnt vmcnt(10)
    s_barrier
    s_add_u32 m0, s51, 114688
    s_add_u32 s7, s4, 2
    s_and_b32 s7, s7, 3
    s_lshl_b32 s7, s7, 7
    s_add_u32 s58, s56, s7
    buffer_load_dwordx4 v16, s[8:11], s58 offen lds
    buffer_load_dwordx4 v17, s[8:11], s58 offen offset:1024 lds
    s_lshl_b32 s6, s46, 11
    s_add_u32 m0, s6, 131072
    s_nop 0
    buffer_load_dwordx4 v34, s[20:23], s73 offen lds
    buffer_load_dwordx4 v35, s[20:23], s73 offen offset:1024 lds
    s_add_u32 m0, s51, 114688
    s_nop 0
    buffer_load_dwordx4 v18, s[8:11], s58 offen offset:2048 lds
    s_getpc_b64 s[64:65]
Lpc0_0:
    s_sub_u32 s64, s64, Lpc0_0-parallel_sum__linear_attn_block__glu_gated_reglu__prompt_kernel
    s_subb_u32 s65, s65, 0
    v_min_u32 v40, 2, v1
    s_mul_i32 s6, s45, 12
    s_mul_i32 s7, s46, 3
    s_add_u32 s6, s6, s7
    v_add_u32 v40, s6, v40
    v_lshlrev_b32 v40, 7, v40
    s_mov_b32 s66, Lcode_end-parallel_sum__linear_attn_block__glu_gated_reglu__prompt_kernel-4
    v_min_u32 v40, s66, v40
    global_load_dword v28, v40, s[64:65]
    buffer_load_dwordx4 v19, s[8:11], s58 offen offset:3072 lds
    s_add_u32 m0, s51, 32768
    s_add_u32 s7, s4, 2
    s_and_b32 s7, s7, 3
    s_mul_i32 s7, s7, s53
    s_add_u32 s59, s52, s7
    buffer_load_dwordx4 v4, s[20:23], s59 offen lds
    buffer_load_dwordx4 v5, s[20:23], s59 offen offset:1024 lds
    buffer_load_dwordx4 v6, s[20:23], s59 offen offset:2048 lds
    buffer_load_dwordx4 v7, s[20:23], s59 offen offset:3072 lds
    s_waitcnt vmcnt(13)
    s_barrier
    s_add_u32 m0, s51, 49152
    s_add_u32 s7, s4, 3
    s_and_b32 s7, s7, 3
    s_mul_i32 s7, s7, s53
    s_add_u32 s59, s52, s7
    buffer_load_dwordx4 v4, s[20:23], s59 offen lds
    s_add_u32 m0, s51, 81920
    s_add_u32 s7, s4, 3
    s_and_b32 s7, s7, 3
    s_lshl_b32 s7, s7, 7
    s_add_u32 s58, s56, s7
    buffer_load_dwordx4 v16, s[8:11], s58 offen lds
    s_add_u32 m0, s51, 49152
    s_nop 0
    buffer_load_dwordx4 v5, s[20:23], s59 offen offset:1024 lds
    s_add_u32 m0, s51, 81920
    s_nop 0
    buffer_load_dwordx4 v17, s[8:11], s58 offen offset:1024 lds
    s_add_u32 m0, s51, 49152
    s_nop 0
    buffer_load_dwordx4 v6, s[20:23], s59 offen offset:2048 lds
    s_add_u32 m0, s51, 81920
    s_nop 0
    buffer_load_dwordx4 v18, s[8:11], s58 offen offset:2048 lds
    s_add_u32 m0, s51, 49152
    s_nop 0
    buffer_load_dwordx4 v7, s[20:23], s59 offen offset:3072 lds
    s_add_u32 m0, s51, 81920
    s_nop 0
    buffer_load_dwordx4 v19, s[8:11], s58 offen offset:3072 lds
    s_add_u32 m0, s51, 65536
    s_add_u32 s7, s4, 0
    s_and_b32 s7, s7, 3
    s_or_b32 s7, s7, 4
    s_mul_i32 s7, s7, s53
    s_add_u32 s59, s52, s7
    buffer_load_dwordx4 v4, s[20:23], s59 offen lds
    buffer_load_dwordx4 v5, s[20:23], s59 offen offset:1024 lds
    buffer_load_dwordx4 v6, s[20:23], s59 offen offset:2048 lds
    buffer_load_dwordx4 v7, s[20:23], s59 offen offset:3072 lds
    s_waitcnt vmcnt(12)
    s_barrier
    s_add_u32 m0, s51, 0
    s_add_u32 s7, s4, 1
    s_and_b32 s7, s7, 3
    s_or_b32 s7, s7, 4
    s_mul_i32 s7, s7, s53
    s_add_u32 s59, s52, s7
    buffer_load_dwordx4 v4, s[20:23], s59 offen lds
    s_add_u32 m0, s51, 98304
    s_add_u32 s7, s4, 0
    s_and_b32 s7, s7, 3
    s_or_b32 s7, s7, 4
    s_lshl_b32 s7, s7, 7
    s_add_u32 s58, s56, s7
    buffer_load_dwordx4 v16, s[8:11], s58 offen lds
    s_add_u32 m0, s51, 0
    s_nop 0
    buffer_load_dwordx4 v5, s[20:23], s59 offen offset:1024 lds
    s_lshl_b32 s6, s46, 11
    s_add_u32 s6, s6, 131072
    v_add_u32 v88, s6, v3
    s_add_u32 m0, s51, 98304
    s_nop 0
    buffer_load_dwordx4 v17, s[8:11], s58 offen offset:1024 lds
    v_mov_b32 v112, 0x3f803f80
    v_mov_b32 v113, 0x3f803f80
    v_mov_b32 v114, 0x3f803f80
    v_mov_b32 v115, 0x3f803f80
    s_add_u32 m0, s51, 0
    s_nop 0
    buffer_load_dwordx4 v6, s[20:23], s59 offen offset:2048 lds
    v_and_b32 v89, 31, v1
    v_lshlrev_b32 v89, 3, v89
    v_cmp_gt_u32 vcc, 32, v1
    v_mov_b32 v90, 2147483632
    s_nop 0
    v_cndmask_b32 v89, v90, v89, vcc
    s_add_u32 m0, s51, 98304
    s_nop 0
    buffer_load_dwordx4 v18, s[8:11], s58 offen offset:2048 lds
    ds_read_b64_tr_b16 v[96:97], v88 offset:0
    ds_read_b64_tr_b16 v[98:99], v88 offset:256
    ds_read_b64_tr_b16 v[100:101], v88 offset:1024
    ds_read_b64_tr_b16 v[102:103], v88 offset:1280
    s_add_u32 m0, s51, 0
    s_nop 0
    buffer_load_dwordx4 v7, s[20:23], s59 offen offset:3072 lds
    s_waitcnt lgkmcnt(0)
    v_mfma_f32_32x32x16_bf16 v[52:67], v[112:115], v[96:99], 0
    v_mfma_f32_32x32x16_bf16 v[52:67], v[112:115], v[100:103], v[52:67]
    s_add_u32 m0, s51, 98304
    s_nop 0
    buffer_load_dwordx4 v19, s[8:11], s58 offen offset:3072 lds
    s_lshl_b32 s6, s48, 4
    s_add_u32 s6, s6, s47
    s_lshl_b32 s6, s6, 2
    s_add_u32 s6, s6, s46
    s_lshl_b32 s6, s6, 8
    s_add_u32 s71, s6, 786432
    s_nop 2
    v_mov_b32 v84, v52
    v_mov_b32 v85, v30
    buffer_store_dwordx2 v[84:85], v89, s[12:15], s71 offen sc1
    s_waitcnt vmcnt(14)
    s_waitcnt vmcnt(13)
    s_barrier
    s_add_u32 m0, s51, 16384
    s_add_u32 s7, s4, 2
    s_and_b32 s7, s7, 3
    s_or_b32 s7, s7, 4
    s_mul_i32 s7, s7, s53
    s_add_u32 s59, s52, s7
    buffer_load_dwordx4 v4, s[20:23], s59 offen lds
    s_add_u32 m0, s51, 114688
    s_add_u32 s7, s4, 1
    s_and_b32 s7, s7, 3
    s_or_b32 s7, s7, 4
    s_lshl_b32 s7, s7, 7
    s_add_u32 s58, s56, s7
    buffer_load_dwordx4 v16, s[8:11], s58 offen lds
    s_add_u32 m0, s51, 16384
    s_nop 0
    buffer_load_dwordx4 v5, s[20:23], s59 offen offset:1024 lds
    s_add_u32 m0, s51, 114688
    s_nop 0
    buffer_load_dwordx4 v17, s[8:11], s58 offen offset:1024 lds
    s_add_u32 m0, s51, 16384
    s_nop 0
    buffer_load_dwordx4 v6, s[20:23], s59 offen offset:2048 lds
    s_add_u32 m0, s51, 114688
    s_nop 0
    buffer_load_dwordx4 v18, s[8:11], s58 offen offset:2048 lds
    s_add_u32 m0, s51, 16384
    s_nop 0
    buffer_load_dwordx4 v7, s[20:23], s59 offen offset:3072 lds
    s_add_u32 m0, s51, 114688
    s_nop 0
    buffer_load_dwordx4 v19, s[8:11], s58 offen offset:3072 lds
    s_waitcnt vmcnt(17)
    s_waitcnt vmcnt(9)
    s_barrier
    s_add_u32 m0, s51, 32768
    s_add_u32 s7, s4, 3
    s_and_b32 s7, s7, 3
    s_or_b32 s7, s7, 4
    s_mul_i32 s7, s7, s53
    s_add_u32 s59, s52, s7
    buffer_load_dwordx4 v4, s[20:23], s59 offen lds
    s_add_u32 m0, s51, 81920
    s_add_u32 s7, s4, 2
    s_and_b32 s7, s7, 3
    s_or_b32 s7, s7, 4
    s_lshl_b32 s7, s7, 7
    s_add_u32 s58, s56, s7
    buffer_load_dwordx4 v16, s[8:11], s58 offen lds
    s_add_u32 m0, s51, 32768
    s_nop 0
    buffer_load_dwordx4 v5, s[20:23], s59 offen offset:1024 lds
    s_add_u32 m0, s51, 131072
    s_nop 0
    buffer_load_dwordx4 v36, s[24:27], s74 offen lds
    buffer_load_dwordx4 v37, s[24:27], s74 offen offset:1024 lds
    s_add_u32 m0, s51, 81920
    s_nop 0
    buffer_load_dwordx4 v17, s[8:11], s58 offen offset:1024 lds
    s_add_u32 m0, s51, 133120
    s_nop 0
    buffer_load_dwordx4 v12, s[28:31], s75 offen lds
    buffer_load_dwordx4 v13, s[28:31], s75 offen offset:1024 lds
    s_add_u32 m0, s51, 32768
    s_nop 0
    buffer_load_dwordx4 v6, s[20:23], s59 offen offset:2048 lds
    s_add_u32 m0, s51, 81920
    s_nop 0
    buffer_load_dwordx4 v18, s[8:11], s58 offen offset:2048 lds
    s_add_u32 m0, s51, 32768
    s_nop 0
    buffer_load_dwordx4 v7, s[20:23], s59 offen offset:3072 lds
    s_add_u32 m0, s51, 81920
    s_nop 0
    buffer_load_dwordx4 v19, s[8:11], s58 offen offset:3072 lds
    s_waitcnt vmcnt(12)
    s_barrier
    s_add_u32 m0, s51, 49152
    s_add_u32 s7, s4, 0
    s_and_b32 s7, s7, 3
    s_mul_i32 s7, s7, 229376
    s_add_u32 s59, s54, s7
    buffer_load_dwordx4 v8, s[24:27], s59 offen lds
    s_add_u32 m0, s51, 98304
    s_add_u32 s7, s4, 3
    s_and_b32 s7, s7, 3
    s_or_b32 s7, s7, 4
    s_lshl_b32 s7, s7, 7
    s_add_u32 s58, s56, s7
    buffer_load_dwordx4 v16, s[8:11], s58 offen lds
    s_add_u32 m0, s51, 49152
    s_nop 0
    buffer_load_dwordx4 v9, s[24:27], s59 offen offset:1024 lds
    v_and_b32 v92, 31, v1
    v_lshlrev_b32 v92, 3, v92
    v_lshrrev_b32 v93, 5, v1
    v_lshl_add_u32 v92, v93, 10, v92
    s_add_u32 m0, s51, 98304
    s_nop 0
    buffer_load_dwordx4 v17, s[8:11], s58 offen offset:1024 lds
    s_lshl_b32 s6, s48, 14
    s_lshl_b32 s7, s46, 8
    s_add_u32 s6, s6, s7
    s_add_u32 s68, s6, 786432
    s_add_u32 m0, s51, 49152
    s_nop 0
    buffer_load_dwordx4 v10, s[24:27], s59 offen offset:2048 lds
    s_add_u32 s69, s68, 0
    buffer_load_dwordx2 v[52:53], v92, s[12:15], s69 offen sc1
    s_add_u32 m0, s51, 98304
    s_nop 0
    buffer_load_dwordx4 v18, s[8:11], s58 offen offset:2048 lds
    s_add_u32 s69, s68, 2048
    buffer_load_dwordx2 v[54:55], v92, s[12:15], s69 offen sc1
    s_add_u32 m0, s51, 49152
    s_nop 0
    buffer_load_dwordx4 v11, s[24:27], s59 offen offset:3072 lds
    s_add_u32 s69, s68, 4096
    buffer_load_dwordx2 v[56:57], v92, s[12:15], s69 offen sc1
    s_add_u32 m0, s51, 98304
    s_nop 0
    buffer_load_dwordx4 v19, s[8:11], s58 offen offset:3072 lds
    s_add_u32 s69, s68, 6144
    buffer_load_dwordx2 v[58:59], v92, s[12:15], s69 offen sc1
    v_and_b32 v44, 31, v1
    v_lshlrev_b32 v45, 4, v44
    s_lshl_b32 s6, s47, 7
    s_lshl_b32 s7, s46, 5
    s_add_u32 s6, s6, s7
    s_lshl_b32 s72, s6, 4
    s_add_u32 s72, s72, 65536
    buffer_load_dwordx4 v[48:51], v45, s[12:15], s72 offen sc1
    s_waitcnt vmcnt(13)
    s_barrier
    s_add_u32 m0, s51, 65536
    s_add_u32 s7, s4, 1
    s_and_b32 s7, s7, 3
    s_mul_i32 s7, s7, 229376
    s_add_u32 s59, s54, s7
    buffer_load_dwordx4 v8, s[24:27], s59 offen lds
    s_add_u32 s69, s68, 8192
    buffer_load_dwordx2 v[60:61], v92, s[12:15], s69 offen sc1
    s_add_u32 s69, s68, 10240
    buffer_load_dwordx2 v[62:63], v92, s[12:15], s69 offen sc1
    buffer_load_dwordx4 v9, s[24:27], s59 offen offset:1024 lds
    s_add_u32 s69, s68, 12288
    buffer_load_dwordx2 v[64:65], v92, s[12:15], s69 offen sc1
    s_add_u32 s69, s68, 14336
    buffer_load_dwordx2 v[66:67], v92, s[12:15], s69 offen sc1
    buffer_load_dwordx4 v10, s[24:27], s59 offen offset:2048 lds
    buffer_load_dwordx4 v11, s[24:27], s59 offen offset:3072 lds
    s_waitcnt vmcnt(8)
    v_cmp_eq_u32 vcc, v50, v30
    v_cmp_eq_u32 s[64:65], v51, v31
    s_nop 0
    s_and_b64 vcc, vcc, s[64:65]
    s_cmp_eq_u64 vcc, -1
    s_cbranch_scc0 Lslow_1
Lback_2:
    v_sub_f32 v48, 0, v48
    v_lshlrev_b32 v44, 3, v44
    s_lshl_b32 s6, s46, 8
    s_add_u32 s6, s6, 151040
    v_add_u32 v44, s6, v44
    ds_write_b64 v44, v[48:49]
    s_barrier
    s_add_u32 m0, s51, 0
    s_add_u32 s7, s4, 2
    s_and_b32 s7, s7, 3
    s_mul_i32 s7, s7, 229376
    s_add_u32 s59, s54, s7
    buffer_load_dwordx4 v8, s[24:27], s59 offen lds
    s_lshl_b32 s6, s46, 12
    s_add_u32 s6, s6, 131072
    v_add_u32 v88, s6, v3
    buffer_load_dwordx4 v9, s[24:27], s59 offen offset:1024 lds
    v_mov_b32 v112, 0x3f803f80
    v_mov_b32 v113, 0x3f803f80
    v_mov_b32 v114, 0x3f803f80
    v_mov_b32 v115, 0x3f803f80
    v_and_b32 v89, 31, v1
    v_lshlrev_b32 v89, 4, v89
    v_cmp_gt_u32 vcc, 32, v1
    v_mov_b32 v90, 2147483632
    s_nop 0
    v_cndmask_b32 v89, v90, v89, vcc
    buffer_load_dwordx4 v10, s[24:27], s59 offen offset:2048 lds
    ds_read_b64_tr_b16 v[96:97], v88 offset:0
    ds_read_b64_tr_b16 v[98:99], v88 offset:256
    ds_read_b64_tr_b16 v[100:101], v88 offset:1024
    ds_read_b64_tr_b16 v[102:103], v88 offset:1280
    ds_read_b64_tr_b16 v[104:105], v88 offset:2048
    ds_read_b64_tr_b16 v[106:107], v88 offset:2304
    ds_read_b64_tr_b16 v[108:109], v88 offset:3072
    ds_read_b64_tr_b16 v[110:111], v88 offset:3328
    buffer_load_dwordx4 v11, s[24:27], s59 offen offset:3072 lds
    s_waitcnt vmcnt(6)
    v_cmp_eq_u32 vcc, v53, v30
    v_cmp_eq_u32 s[64:65], v55, v30
    s_nop 0
    s_and_b64 vcc, vcc, s[64:65]
    v_cmp_eq_u32 s[64:65], v57, v30
    s_nop 0
    s_and_b64 vcc, vcc, s[64:65]
    v_cmp_eq_u32 s[64:65], v59, v30
    s_nop 0
    s_and_b64 vcc, vcc, s[64:65]
    v_cmp_eq_u32 s[64:65], v61, v30
    s_nop 0
    s_and_b64 vcc, vcc, s[64:65]
    v_cmp_eq_u32 s[64:65], v63, v30
    s_nop 0
    s_and_b64 vcc, vcc, s[64:65]
    v_cmp_eq_u32 s[64:65], v65, v30
    s_nop 0
    s_and_b64 vcc, vcc, s[64:65]
    v_cmp_eq_u32 s[64:65], v67, v30
    s_nop 0
    s_and_b64 vcc, vcc, s[64:65]
    s_cmp_eq_u64 vcc, -1
    s_cbranch_scc0 Lslow_3
Lback_4:
    v_add_f32 v52, v52, v54
    v_add_f32 v52, v52, v56
    v_add_f32 v52, v52, v58
    v_add_f32 v52, v52, v60
    v_add_f32 v52, v52, v62
    v_add_f32 v52, v52, v64
    v_add_f32 v52, v52, v66
    v_mov_b32 v56, v52
    s_nop 1
    v_permlane32_swap_b32 v52, v56
    v_add_f32 v52, v52, v56
    v_cvt_pk_bf16_f32 v56, v52, v52
    v_lshlrev_b32 v56, 16, v56
    v_sub_f32 v56, v52, v56
    v_cvt_pk_bf16_f32 v52, v52, v56
    s_lshl_b32 s6, s46, 7
    v_add_u32 v93, s6, v25
    ds_write_b32 v93, v52
    s_waitcnt lgkmcnt(0)
    s_barrier
    s_add_u32 m0, s51, 16384
    s_add_u32 s7, s4, 3
    s_and_b32 s7, s7, 3
    s_mul_i32 s7, s7, 229376
    s_add_u32 s59, s54, s7
    buffer_load_dwordx4 v8, s[24:27], s59 offen lds
    v_mfma_f32_32x32x16_bf16 v[52:67], v[112:115], v[96:99], 0
    v_mfma_f32_32x32x16_bf16 v[52:67], v[112:115], v[100:103], v[52:67]
    v_mfma_f32_32x32x16_bf16 v[68:83], v[112:115], v[104:107], 0
    v_mfma_f32_32x32x16_bf16 v[68:83], v[112:115], v[108:111], v[68:83]
    s_lshl_b32 s6, s48, 4
    s_add_u32 s6, s6, s47
    s_lshl_b32 s6, s6, 2
    s_add_u32 s6, s6, s46
    s_lshl_b32 s6, s6, 9
    s_add_u32 s71, s6, 262144
    buffer_load_dwordx4 v9, s[24:27], s59 offen offset:1024 lds
    s_bfe_u32 s6, s5, 524312
    s_lshl_b32 s6, s6, 16
    s_lshl_b32 s7, s81, 7
    s_add_u32 s75, s6, s7
    buffer_load_dwordx4 a[0:3], v20, s[32:35], s75 offen
    buffer_load_dwordx4 a[4:7], v21, s[32:35], s75 offen offset:1024
    buffer_load_dwordx4 a[8:11], v22, s[32:35], s75 offen offset:2048
    buffer_load_dwordx4 a[12:15], v23, s[32:35], s75 offen offset:3072
    s_add_u32 s75, s75, 32768
    buffer_load_dwordx4 a[16:19], v20, s[32:35], s75 offen
    buffer_load_dwordx4 a[20:23], v21, s[32:35], s75 offen offset:1024
    buffer_load_dwordx4 v10, s[24:27], s59 offen offset:2048 lds
    buffer_load_dwordx4 a[24:27], v22, s[32:35], s75 offen offset:2048
    buffer_load_dwordx4 a[28:31], v23, s[32:35], s75 offen offset:3072
    s_bfe_u32 s6, s3, 524288
    s_lshl_b32 s6, s6, 16
    s_lshl_b32 s7, s81, 7
    s_add_u32 s75, s6, s7
    buffer_load_dwordx4 a[32:35], v20, s[32:35], s75 offen
    buffer_load_dwordx4 a[36:39], v21, s[32:35], s75 offen offset:1024
    buffer_load_dwordx4 a[40:43], v22, s[32:35], s75 offen offset:2048
    buffer_load_dwordx4 a[44:47], v23, s[32:35], s75 offen offset:3072
    s_add_u32 s75, s75, 32768
    buffer_load_dwordx4 a[48:51], v20, s[32:35], s75 offen
    buffer_load_dwordx4 v11, s[24:27], s59 offen offset:3072 lds
    buffer_load_dwordx4 a[52:55], v21, s[32:35], s75 offen offset:1024
    buffer_load_dwordx4 a[56:59], v22, s[32:35], s75 offen offset:2048
    buffer_load_dwordx4 a[60:63], v23, s[32:35], s75 offen offset:3072
    s_waitcnt vmcnt(24)
    s_barrier
    v_mov_b32 v84, v52
    v_mov_b32 v85, v68
    v_mov_b32 v86, v30
    v_mov_b32 v87, v30
    buffer_store_dwordx4 v[84:87], v89, s[12:15], s71 offen sc1
    s_add_u32 m0, s51, 32768
    s_add_u32 s7, s4, 0
    s_and_b32 s7, s7, 3
    s_or_b32 s7, s7, 4
    s_mul_i32 s7, s7, 229376
    s_add_u32 s59, s54, s7
    buffer_load_dwordx4 v8, s[24:27], s59 offen lds
    v_lshrrev_b32 v38, 4, v1
    v_lshlrev_b32 v38, 3, v38
    v_bfe_u32 v39, v1, 2, 2
    v_add_u32 v38, v38, v39
    buffer_load_dwordx4 v9, s[24:27], s59 offen offset:1024 lds
    s_movk_i32 s7, 136
    v_mul_lo_u32 v38, v38, s7
    v_and_b32 v39, 3, v1
    v_lshl_add_u32 v38, v39, 3, v38
    s_lshl_b32 s6, s46, 5
    s_add_u32 s6, s6, 81920
    v_add_u32 v38, s6, v38
    buffer_load_dwordx4 v10, s[24:27], s59 offen offset:2048 lds
    ds_read_b64_tr_b16 v[52:53], v38 offset:0
    ds_read_b64_tr_b16 v[54:55], v38 offset:544
    ds_read_b64_tr_b16 v[56:57], v38 offset:17408
    ds_read_b64_tr_b16 v[58:59], v38 offset:17952
    ds_read_b64_tr_b16 v[60:61], v38 offset:4352
    ds_read_b64_tr_b16 v[62:63], v38 offset:4896
    buffer_load_dwordx4 v11, s[24:27], s59 offen offset:3072 lds
    ds_read_b64_tr_b16 v[64:65], v38 offset:21760
    ds_read_b64_tr_b16 v[66:67], v38 offset:22304
    ds_read_b64_tr_b16 v[68:69], v38 offset:8704
    ds_read_b64_tr_b16 v[70:71], v38 offset:9248
    ds_read_b64_tr_b16 v[72:73], v38 offset:26112
    ds_read_b64_tr_b16 v[74:75], v38 offset:26656
    ds_read_b64_tr_b16 v[76:77], v38 offset:13056
    ds_read_b64_tr_b16 v[78:79], v38 offset:13600
    ds_read_b64_tr_b16 v[80:81], v38 offset:30464
    ds_read_b64_tr_b16 v[82:83], v38 offset:31008
    v_mov_b32 v84, 0x3f803f80
    v_mov_b32 v85, 0x3f803f80
    v_mov_b32 v86, 0x3f803f80
    v_mov_b32 v87, 0x3f803f80
    s_waitcnt vmcnt(25)
    s_barrier
    s_add_u32 m0, s51, 49152
    s_add_u32 s7, s4, 1
    s_and_b32 s7, s7, 3
    s_or_b32 s7, s7, 4
    s_mul_i32 s7, s7, 229376
    s_add_u32 s59, s54, s7
    buffer_load_dwordx4 v8, s[24:27], s59 offen lds
    s_waitcnt lgkmcnt(0)
    v_mfma_f32_16x16x32_bf16 v[88:91], v[56:59], v[52:55], 0
    v_mfma_f32_16x16x32_bf16 v[48:51], v[84:87], v[52:55], 0
    buffer_load_dwordx4 v9, s[24:27], s59 offen offset:1024 lds
    v_mfma_f32_16x16x32_bf16 v[88:91], v[64:67], v[60:63], v[88:91]
    v_mfma_f32_16x16x32_bf16 v[48:51], v[84:87], v[60:63], v[48:51]
    v_mfma_f32_16x16x32_bf16 v[88:91], v[72:75], v[68:71], v[88:91]
    v_mfma_f32_16x16x32_bf16 v[48:51], v[84:87], v[68:71], v[48:51]
    v_mfma_f32_16x16x32_bf16 v[88:91], v[80:83], v[76:79], v[88:91]
    v_mfma_f32_16x16x32_bf16 v[48:51], v[84:87], v[76:79], v[48:51]
    buffer_load_dwordx4 v10, s[24:27], s59 offen offset:2048 lds
    s_lshl_b32 s6, s49, 2
    s_add_u32 s6, s6, s46
    s_lshl_b32 s7, s6, 4
    s_add_u32 s7, s7, s47
    s_lshl_b32 s7, s7, 10
    s_add_u32 s73, s7, 10485760
    s_lshl_b32 s7, s6, 10
    s_lshl_b32 s72, s47, 6
    s_add_u32 s7, s7, s72
    s_add_u32 s72, s7, 11010048
    s_lshl_b32 s7, s6, 7
    s_lshl_b32 s6, s47, 3
    s_add_u32 s7, s7, s6
    s_add_u32 s71, s7, 11075584
    v_cmp_gt_u32 vcc, 16, v1
    v_mov_b32 v39, 2147483632
    v_lshlrev_b32 v38, 2, v1
    v_cndmask_b32 v38, v39, v38, vcc
    buffer_load_dwordx4 v11, s[24:27], s59 offen offset:3072 lds
    buffer_store_dwordx4 v[88:91], v2, s[12:15], s73 offen sc1
    buffer_store_dword v48, v38, s[12:15], s72 offen sc1
    s_waitcnt vmcnt(14)
    s_barrier
    s_add_u32 m0, s51, 65536
    s_add_u32 s7, s4, 2
    s_and_b32 s7, s7, 3
    s_or_b32 s7, s7, 4
    s_mul_i32 s7, s7, 229376
    s_add_u32 s59, s54, s7
    buffer_load_dwordx4 v8, s[24:27], s59 offen lds
    buffer_load_dwordx4 v9, s[24:27], s59 offen offset:1024 lds
    buffer_load_dwordx4 v10, s[24:27], s59 offen offset:2048 lds
    buffer_load_dwordx4 v11, s[24:27], s59 offen offset:3072 lds
    s_waitcnt vmcnt(10)
    s_barrier
    s_add_u32 m0, s51, 0
    s_add_u32 s7, s4, 3
    s_and_b32 s7, s7, 3
    s_or_b32 s7, s7, 4
    s_mul_i32 s7, s7, 229376
    s_add_u32 s59, s54, s7
    buffer_load_dwordx4 v8, s[24:27], s59 offen lds
    s_waitcnt vmcnt(5)
    buffer_store_dwordx2 v[30:31], v26, s[12:15], s71 offen sc1
    v_and_b32 v92, 31, v1
    v_lshlrev_b32 v92, 4, v92
    v_lshrrev_b32 v93, 5, v1
    v_lshl_add_u32 v92, v93, 11, v92
    buffer_load_dwordx4 v9, s[24:27], s59 offen offset:1024 lds
    s_lshl_b32 s6, s48, 15
    s_lshl_b32 s7, s46, 9
    s_add_u32 s6, s6, s7
    s_add_u32 s68, s6, 262144
    s_add_u32 s69, s68, 0
    buffer_load_dwordx4 v[52:55], v92, s[12:15], s69 offen sc1
    s_add_u32 s69, s68, 4096
    buffer_load_dwordx4 v[56:59], v92, s[12:15], s69 offen sc1
    buffer_load_dwordx4 v10, s[24:27], s59 offen offset:2048 lds
    s_add_u32 s69, s68, 8192
    buffer_load_dwordx4 v[60:63], v92, s[12:15], s69 offen sc1
    s_add_u32 s69, s68, 12288
    buffer_load_dwordx4 v[64:67], v92, s[12:15], s69 offen sc1
    s_bfe_u32 s6, s5, 524288
    s_lshl_b32 s6, s6, 16
    s_lshl_b32 s7, s81, 7
    s_add_u32 s74, s6, s7
    buffer_load_dwordx4 v11, s[24:27], s59 offen offset:3072 lds
    s_barrier
    s_add_u32 m0, s51, 16384
    s_and_b32 s7, s46, 1
    s_add_u32 s7, s7, s4
    s_add_u32 s7, s7, 0
    s_and_b32 s7, s7, 3
    s_mul_i32 s7, s7, s55
    s_add_u32 s59, s44, s7
    buffer_load_dwordx4 v12, s[28:31], s59 offen lds
    s_add_u32 s69, s68, 16384
    buffer_load_dwordx4 v[68:71], v92, s[12:15], s69 offen sc1
    s_add_u32 s69, s68, 20480
    buffer_load_dwordx4 v[72:75], v92, s[12:15], s69 offen sc1
    buffer_load_dwordx4 v13, s[28:31], s59 offen offset:1024 lds
    s_add_u32 s69, s68, 24576
    buffer_load_dwordx4 v[76:79], v92, s[12:15], s69 offen sc1
    s_add_u32 s69, s68, 28672
    buffer_load_dwordx4 v[80:83], v92, s[12:15], s69 offen sc1
    s_add_u32 m0, s57, 81920
    s_nop 0
    buffer_load_dwordx4 v20, s[32:35], s74 offen lds
    s_add_u32 m0, s51, 16384
    s_nop 0
    buffer_load_dwordx4 v14, s[28:31], s59 offen offset:2048 lds
    buffer_load_dwordx4 v15, s[28:31], s59 offen offset:3072 lds
    s_waitcnt vmcnt(18)
    s_barrier
    s_add_u32 m0, s51, 32768
    s_and_b32 s7, s46, 1
    s_add_u32 s7, s7, s4
    s_add_u32 s7, s7, 2
    s_and_b32 s7, s7, 3
    s_mul_i32 s7, s7, s55
    s_add_u32 s59, s44, s7
    buffer_load_dwordx4 v12, s[28:31], s59 offen lds
    s_add_u32 m0, s57, 81920
    s_nop 0
    buffer_load_dwordx4 v21, s[32:35], s74 offen offset:1024 lds
    buffer_load_dwordx4 v22, s[32:35], s74 offen offset:2048 lds
    s_add_u32 m0, s51, 32768
    s_nop 0
    buffer_load_dwordx4 v13, s[28:31], s59 offen offset:1024 lds
    s_add_u32 m0, s57, 81920
    s_nop 0
    buffer_load_dwordx4 v23, s[32:35], s74 offen offset:3072 lds
    s_add_u32 m0, s57, 86016
    s_add_u32 s74, s74, 32768
    buffer_load_dwordx4 v20, s[32:35], s74 offen lds
    s_add_u32 m0, s51, 32768
    s_nop 0
    buffer_load_dwordx4 v14, s[28:31], s59 offen offset:2048 lds
    s_add_u32 m0, s57, 86016
    s_nop 0
    buffer_load_dwordx4 v21, s[32:35], s74 offen offset:1024 lds
    s_add_u32 m0, s51, 32768
    s_nop 0
    buffer_load_dwordx4 v15, s[28:31], s59 offen offset:3072 lds
    s_waitcnt vmcnt(12)
    v_cmp_eq_u32 vcc, v55, v30
    v_cmp_eq_u32 s[64:65], v59, v30
    s_nop 0
    s_and_b64 vcc, vcc, s[64:65]
    v_cmp_eq_u32 s[64:65], v63, v30
    s_nop 0
    s_and_b64 vcc, vcc, s[64:65]
    v_cmp_eq_u32 s[64:65], v67, v30
    s_nop 0
    s_and_b64 vcc, vcc, s[64:65]
    v_cmp_eq_u32 s[64:65], v71, v30
    s_nop 0
    s_and_b64 vcc, vcc, s[64:65]
    v_cmp_eq_u32 s[64:65], v75, v30
    s_nop 0
    s_and_b64 vcc, vcc, s[64:65]
    v_cmp_eq_u32 s[64:65], v79, v30
    s_nop 0
    s_and_b64 vcc, vcc, s[64:65]
    v_cmp_eq_u32 s[64:65], v83, v30
    s_nop 0
    s_and_b64 vcc, vcc, s[64:65]
    s_cmp_eq_u64 vcc, -1
    s_cbranch_scc0 Lslow_5
Lback_6:
    v_add_f32 v52, v52, v56
    v_add_f32 v53, v53, v57
    v_add_f32 v52, v52, v60
    v_add_f32 v53, v53, v61
    v_add_f32 v52, v52, v64
    v_add_f32 v53, v53, v65
    v_add_f32 v52, v52, v68
    v_add_f32 v53, v53, v69
    v_add_f32 v52, v52, v72
    v_add_f32 v53, v53, v73
    v_add_f32 v52, v52, v76
    v_add_f32 v53, v53, v77
    v_add_f32 v52, v52, v80
    v_add_f32 v53, v53, v81
    v_mov_b32 v56, v52
    v_mov_b32 v57, v53
    s_nop 0
    v_permlane32_swap_b32 v52, v56
    v_permlane32_swap_b32 v53, v57
    v_add_f32 v52, v52, v56
    v_add_f32 v53, v53, v57
    s_barrier
    s_add_u32 m0, s51, 49152
    s_and_b32 s7, s46, 1
    s_add_u32 s7, s7, s4
    s_add_u32 s7, s7, 0
    s_and_b32 s7, s7, 3
    s_or_b32 s7, s7, 4
    s_mul_i32 s7, s7, s55
    s_add_u32 s59, s44, s7
    buffer_load_dwordx4 v12, s[28:31], s59 offen lds
    v_cvt_pk_bf16_f32 v56, v52, v52
    v_cvt_pk_bf16_f32 v57, v53, v53
    v_lshlrev_b32 v56, 16, v56
    v_lshlrev_b32 v57, 16, v57
    v_sub_f32 v56, v52, v56
    v_sub_f32 v57, v53, v57
    v_cvt_pk_bf16_f32 v52, v52, v56
    v_cvt_pk_bf16_f32 v53, v53, v57
    buffer_load_dwordx4 v13, s[28:31], s59 offen offset:1024 lds
    s_lshl_b32 s6, s46, 7
    v_add_u32 v93, s6, v25
    ds_write_b32 v93, v52 offset:512
    s_lshr_b32 s6, s46, 1
    s_lshl_b32 s6, s6, 7
    v_add_u32 v93, s6, v25
    ds_write_b32 v93, v53 offset:1024
    s_add_u32 m0, s57, 86016
    s_nop 0
    buffer_load_dwordx4 v22, s[32:35], s74 offen offset:2048 lds
    buffer_load_dwordx4 v23, s[32:35], s74 offen offset:3072 lds
    s_add_u32 m0, s51, 49152
    s_nop 0
    buffer_load_dwordx4 v14, s[28:31], s59 offen offset:2048 lds
    buffer_load_dwordx4 v15, s[28:31], s59 offen offset:3072 lds
    s_waitcnt vmcnt(15)
    s_waitcnt lgkmcnt(0)
    s_barrier
    v_bfe_u32 v27, v1, 1, 3
    v_lshlrev_b32 v27, 2, v27
    v_and_b32 v32, 1, v1
    v_add_u32 v27, v27, v32
    v_add_u32 v27, 2, v27
    v_lshlrev_b32 v27, 3, v27
    s_mul_i32 s72, s80, 768
    s_add_u32 s72, s72, 8192
    buffer_load_dwordx2 v[32:33], v27, s[12:15], s72 offen sc1
    s_add_u32 m0, s51, 65536
    s_and_b32 s7, s46, 1
    s_add_u32 s7, s7, s4
    s_add_u32 s7, s7, 2
    s_and_b32 s7, s7, 3
    s_or_b32 s7, s7, 4
    s_mul_i32 s7, s7, s55
    s_add_u32 s59, s44, s7
    buffer_load_dwordx4 v12, s[28:31], s59 offen lds
    s_bfe_u32 s6, s3, 524296
    s_lshl_b32 s6, s6, 16
    s_lshl_b32 s7, s81, 7
    s_add_u32 s75, s6, s7
    buffer_load_dwordx4 a[64:67], v20, s[32:35], s75 offen
    buffer_load_dwordx4 a[68:71], v21, s[32:35], s75 offen offset:1024
    buffer_load_dwordx4 v13, s[28:31], s59 offen offset:1024 lds
    buffer_load_dwordx4 a[72:75], v22, s[32:35], s75 offen offset:2048
    buffer_load_dwordx4 a[76:79], v23, s[32:35], s75 offen offset:3072
    s_add_u32 s75, s75, 32768
    buffer_load_dwordx4 a[80:83], v20, s[32:35], s75 offen
    buffer_load_dwordx4 a[84:87], v21, s[32:35], s75 offen offset:1024
    buffer_load_dwordx4 a[88:91], v22, s[32:35], s75 offen offset:2048
    buffer_load_dwordx4 a[92:95], v23, s[32:35], s75 offen offset:3072
    s_bfe_u32 s6, s3, 524304
    s_cmp_lt_u32 s6, 28
    s_cselect_b32 s20, s32, s36
    s_cselect_b32 s21, s33, s37
    s_cselect_b32 s22, s34, s38
    s_cselect_b32 s7, 0, 28
    s_sub_u32 s6, s6, s7
    s_lshl_b32 s6, s6, 16
    s_lshl_b32 s7, s81, 7
    s_add_u32 s75, s6, s7
    buffer_load_dwordx4 v14, s[28:31], s59 offen offset:2048 lds
    buffer_load_dwordx4 a[96:99], v20, s[20:23], s75 offen
    buffer_load_dwordx4 a[100:103], v21, s[20:23], s75 offen offset:1024
    buffer_load_dwordx4 a[104:107], v22, s[20:23], s75 offen offset:2048
    buffer_load_dwordx4 a[108:111], v23, s[20:23], s75 offen offset:3072
    s_add_u32 s75, s75, 32768
    buffer_load_dwordx4 a[112:115], v20, s[20:23], s75 offen
    buffer_load_dwordx4 a[116:119], v21, s[20:23], s75 offen offset:1024
    buffer_load_dwordx4 a[120:123], v22, s[20:23], s75 offen offset:2048
    buffer_load_dwordx4 a[124:127], v23, s[20:23], s75 offen offset:3072
    buffer_load_dwordx4 v15, s[28:31], s59 offen offset:3072 lds
    s_waitcnt vmcnt(27)
    s_barrier
    s_waitcnt vmcnt(21)
    s_waitcnt vmcnt(20)
    v_cmp_eq_u32 vcc, v32, v30
    v_cmp_eq_u32 s[64:65], v33, v31
    s_nop 0
    s_and_b64 vcc, vcc, s[64:65]
    s_cmp_eq_u64 vcc, -1
    s_cbranch_scc0 Lslow_7
Lback_8:
    s_barrier
    buffer_store_dwordx2 v[30:31], v26, s[12:15], s77 offen offset:256 sc1
    s_bfe_u32 s6, s5, 524296
    s_lshl_b32 s6, s6, 16
    s_lshl_b32 s7, s81, 7
    s_add_u32 s74, s6, s7
    s_add_u32 m0, s57, 0
    s_nop 0
    buffer_load_dwordx4 v20, s[32:35], s74 offen lds
    buffer_load_dwordx4 v21, s[32:35], s74 offen offset:1024 lds
    buffer_load_dwordx4 v22, s[32:35], s74 offen offset:2048 lds
    buffer_load_dwordx4 v23, s[32:35], s74 offen offset:3072 lds
    s_add_u32 m0, s57, 4096
    s_add_u32 s74, s74, 32768
    buffer_load_dwordx4 v20, s[32:35], s74 offen lds
    buffer_load_dwordx4 v21, s[32:35], s74 offen offset:1024 lds
    buffer_load_dwordx4 v22, s[32:35], s74 offen offset:2048 lds
    buffer_load_dwordx4 v23, s[32:35], s74 offen offset:3072 lds
    s_waitcnt vmcnt(9)
    s_barrier
    s_barrier
    s_bfe_u32 s6, s5, 524304
    s_lshl_b32 s6, s6, 16
    s_lshl_b32 s7, s81, 7
    s_add_u32 s74, s6, s7
    s_add_u32 m0, s57, 32768
    s_nop 0
    buffer_load_dwordx4 v20, s[32:35], s74 offen lds
    buffer_load_dwordx4 v21, s[32:35], s74 offen offset:1024 lds
    buffer_load_dwordx4 v22, s[32:35], s74 offen offset:2048 lds
    buffer_load_dwordx4 v23, s[32:35], s74 offen offset:3072 lds
    s_add_u32 m0, s57, 36864
    s_add_u32 s74, s74, 32768
    buffer_load_dwordx4 v20, s[32:35], s74 offen lds
    buffer_load_dwordx4 v21, s[32:35], s74 offen offset:1024 lds
    buffer_load_dwordx4 v22, s[32:35], s74 offen offset:2048 lds
    buffer_load_dwordx4 v23, s[32:35], s74 offen offset:3072 lds
    s_barrier
    s_add_u32 s6, s57, 114688
    v_add_u32 v40, s6, v2
    ds_write_b128 v40, a[0:3] offset:0
    ds_write_b128 v40, a[4:7] offset:1024
    ds_write_b128 v40, a[8:11] offset:2048
    ds_write_b128 v40, a[12:15] offset:3072
    ds_write_b128 v40, a[16:19] offset:4096
    ds_write_b128 v40, a[20:23] offset:5120
    ds_write_b128 v40, a[24:27] offset:6144
    ds_write_b128 v40, a[28:31] offset:7168
    v_and_b32 v27, 31, v1
    v_lshlrev_b32 v27, 3, v27
    s_mul_i32 s72, s80, 768
    s_add_u32 s72, s72, 8448
    buffer_load_dwordx2 v[32:33], v27, s[12:15], s72 offen sc1
    s_waitcnt vmcnt(0)
    v_cmp_eq_u32 vcc, v32, v30
    v_cmp_eq_u32 s[64:65], v33, v31
    s_nop 0
    s_and_b64 vcc, vcc, s[64:65]
    s_cmp_eq_u64 vcc, -1
    s_cbranch_scc0 Lslow_9
Lback_10:
    s_barrier
    s_barrier
    buffer_store_dwordx2 v[30:31], v26, s[12:15], s77 offen offset:512 sc1
    s_add_u32 s6, s57, 81920
    v_add_u32 v40, s6, v2
    ds_write_b128 v40, a[32:35] offset:0
    ds_write_b128 v40, a[36:39] offset:1024
    ds_write_b128 v40, a[40:43] offset:2048
    ds_write_b128 v40, a[44:47] offset:3072
    ds_write_b128 v40, a[48:51] offset:4096
    ds_write_b128 v40, a[52:55] offset:5120
    ds_write_b128 v40, a[56:59] offset:6144
    ds_write_b128 v40, a[60:63] offset:7168
    s_barrier
    s_add_u32 s6, s57, 0
    v_add_u32 v40, s6, v2
    ds_write_b128 v40, a[64:67] offset:0
    ds_write_b128 v40, a[68:71] offset:1024
    ds_write_b128 v40, a[72:75] offset:2048
    ds_write_b128 v40, a[76:79] offset:3072
    ds_write_b128 v40, a[80:83] offset:4096
    ds_write_b128 v40, a[84:87] offset:5120
    ds_write_b128 v40, a[88:91] offset:6144
    ds_write_b128 v40, a[92:95] offset:7168
    s_waitcnt lgkmcnt(15)
    s_barrier
    s_add_u32 s6, s57, 32768
    v_add_u32 v40, s6, v2
    ds_write_b128 v40, a[96:99] offset:0
    ds_write_b128 v40, a[100:103] offset:1024
    ds_write_b128 v40, a[104:107] offset:2048
    ds_write_b128 v40, a[108:111] offset:3072
    ds_write_b128 v40, a[112:115] offset:4096
    ds_write_b128 v40, a[116:119] offset:5120
    ds_write_b128 v40, a[120:123] offset:6144
    ds_write_b128 v40, a[124:127] offset:7168
    s_waitcnt lgkmcnt(15)
    s_barrier
    v_and_b32 v27, 31, v1
    v_lshlrev_b32 v27, 3, v27
    s_mul_i32 s72, s80, 768
    s_add_u32 s72, s72, 8704
    buffer_load_dwordx2 v[32:33], v27, s[12:15], s72 offen sc1
    s_bfe_u32 s6, s3, 524312
    s_cmp_lt_u32 s6, 28
    s_cselect_b32 s20, s32, s36
    s_cselect_b32 s21, s33, s37
    s_cselect_b32 s22, s34, s38
    s_cselect_b32 s7, 0, 28
    s_sub_u32 s6, s6, s7
    s_lshl_b32 s6, s6, 16
    s_lshl_b32 s7, s81, 7
    s_add_u32 s74, s6, s7
    s_add_u32 m0, s57, 114688
    s_nop 0
    buffer_load_dwordx4 v20, s[20:23], s74 offen lds
    buffer_load_dwordx4 v21, s[20:23], s74 offen offset:1024 lds
    buffer_load_dwordx4 v22, s[20:23], s74 offen offset:2048 lds
    buffer_load_dwordx4 v23, s[20:23], s74 offen offset:3072 lds
    s_add_u32 m0, s57, 118784
    s_add_u32 s74, s74, 32768
    buffer_load_dwordx4 v20, s[20:23], s74 offen lds
    buffer_load_dwordx4 v21, s[20:23], s74 offen offset:1024 lds
    buffer_load_dwordx4 v22, s[20:23], s74 offen offset:2048 lds
    buffer_load_dwordx4 v23, s[20:23], s74 offen offset:3072 lds
    s_waitcnt lgkmcnt(8)
    s_waitcnt vmcnt(8)
    v_cmp_eq_u32 vcc, v32, v30
    v_cmp_eq_u32 s[64:65], v33, v31
    s_nop 0
    s_and_b64 vcc, vcc, s[64:65]
    s_cmp_eq_u64 vcc, -1
    s_cbranch_scc0 Lslow_11
Lback_12:
    s_barrier
    s_bfe_u32 s6, s63, 524288
    s_cmp_lt_u32 s6, 28
    s_cselect_b32 s20, s32, s36
    s_cselect_b32 s21, s33, s37
    s_cselect_b32 s22, s34, s38
    s_cselect_b32 s7, 0, 28
    s_sub_u32 s6, s6, s7
    s_lshl_b32 s6, s6, 16
    s_lshl_b32 s7, s81, 7
    s_add_u32 s74, s6, s7
    s_add_u32 m0, s57, 81920
    s_nop 0
    buffer_load_dwordx4 v20, s[20:23], s74 offen lds
    buffer_load_dwordx4 v21, s[20:23], s74 offen offset:1024 lds
    buffer_load_dwordx4 v22, s[20:23], s74 offen offset:2048 lds
    buffer_load_dwordx4 v23, s[20:23], s74 offen offset:3072 lds
    s_add_u32 m0, s57, 86016
    s_add_u32 s74, s74, 32768
    buffer_load_dwordx4 v20, s[20:23], s74 offen lds
    buffer_load_dwordx4 v21, s[20:23], s74 offen offset:1024 lds
    buffer_load_dwordx4 v22, s[20:23], s74 offen offset:2048 lds
    buffer_load_dwordx4 v23, s[20:23], s74 offen offset:3072 lds
    s_waitcnt lgkmcnt(0)
    s_barrier
    s_waitcnt vmcnt(8)
    s_barrier
    s_waitcnt vmcnt(0)
    s_barrier
    s_cmp_eq_u32 s2, 0
    s_cselect_b64 vcc, -1, 0
    s_cmp_eq_u32 s46, 0
    s_cselect_b64 vcc, vcc, 0
    v_mov_b32 v40, 2147483632
    s_nop 0
    v_cndmask_b32 v40, v40, v26, vcc
    buffer_store_dwordx2 v[30:31], v40, s[12:15], 0 offen sc1
    s_endpgm
Lhodd:
    s_waitcnt vmcnt(10)
    s_barrier
    s_add_u32 m0, s51, 114688
    s_add_u32 s7, s4, 2
    s_and_b32 s7, s7, 3
    s_lshl_b32 s7, s7, 7
    s_add_u32 s58, s56, s7
    buffer_load_dwordx4 v16, s[8:11], s58 offen lds
    buffer_load_dwordx4 v17, s[8:11], s58 offen offset:1024 lds
    s_lshl_b32 s6, s46, 11
    s_add_u32 m0, s6, 131072
    s_nop 0
    buffer_load_dwordx4 v34, s[20:23], s73 offen lds
    buffer_load_dwordx4 v35, s[20:23], s73 offen offset:1024 lds
    s_add_u32 m0, s51, 114688
    s_nop 0
    buffer_load_dwordx4 v18, s[8:11], s58 offen offset:2048 lds
    s_getpc_b64 s[64:65]
Lpc0_1:
    s_sub_u32 s64, s64, Lpc0_1-parallel_sum__linear_attn_block__glu_gated_reglu__prompt_kernel
    s_subb_u32 s65, s65, 0
    v_min_u32 v40, 2, v1
    s_mul_i32 s6, s45, 12
    s_mul_i32 s7, s46, 3
    s_add_u32 s6, s6, s7
    v_add_u32 v40, s6, v40
    v_lshlrev_b32 v40, 7, v40
    s_mov_b32 s66, Lcode_end-parallel_sum__linear_attn_block__glu_gated_reglu__prompt_kernel-4
    v_min_u32 v40, s66, v40
    global_load_dword v28, v40, s[64:65]
    buffer_load_dwordx4 v19, s[8:11], s58 offen offset:3072 lds
    s_add_u32 m0, s51, 32768
    s_add_u32 s7, s4, 2
    s_and_b32 s7, s7, 3
    s_mul_i32 s7, s7, s53
    s_add_u32 s59, s52, s7
    buffer_load_dwordx4 v4, s[20:23], s59 offen lds
    buffer_load_dwordx4 v5, s[20:23], s59 offen offset:1024 lds
    buffer_load_dwordx4 v6, s[20:23], s59 offen offset:2048 lds
    buffer_load_dwordx4 v7, s[20:23], s59 offen offset:3072 lds
    s_waitcnt vmcnt(13)
    s_barrier
    s_add_u32 m0, s51, 49152
    s_add_u32 s7, s4, 3
    s_and_b32 s7, s7, 3
    s_mul_i32 s7, s7, s53
    s_add_u32 s59, s52, s7
    buffer_load_dwordx4 v4, s[20:23], s59 offen lds
    s_add_u32 m0, s51, 81920
    s_add_u32 s7, s4, 3
    s_and_b32 s7, s7, 3
    s_lshl_b32 s7, s7, 7
    s_add_u32 s58, s56, s7
    buffer_load_dwordx4 v16, s[8:11], s58 offen lds
    s_add_u32 m0, s51, 49152
    s_nop 0
    buffer_load_dwordx4 v5, s[20:23], s59 offen offset:1024 lds
    s_add_u32 m0, s51, 81920
    s_nop 0
    buffer_load_dwordx4 v17, s[8:11], s58 offen offset:1024 lds
    s_add_u32 m0, s51, 49152
    s_nop 0
    buffer_load_dwordx4 v6, s[20:23], s59 offen offset:2048 lds
    s_add_u32 m0, s51, 81920
    s_nop 0
    buffer_load_dwordx4 v18, s[8:11], s58 offen offset:2048 lds
    s_add_u32 m0, s51, 49152
    s_nop 0
    buffer_load_dwordx4 v7, s[20:23], s59 offen offset:3072 lds
    s_add_u32 m0, s51, 81920
    s_nop 0
    buffer_load_dwordx4 v19, s[8:11], s58 offen offset:3072 lds
    s_add_u32 m0, s51, 65536
    s_add_u32 s7, s4, 0
    s_and_b32 s7, s7, 3
    s_or_b32 s7, s7, 4
    s_mul_i32 s7, s7, s53
    s_add_u32 s59, s52, s7
    buffer_load_dwordx4 v4, s[20:23], s59 offen lds
    buffer_load_dwordx4 v5, s[20:23], s59 offen offset:1024 lds
    buffer_load_dwordx4 v6, s[20:23], s59 offen offset:2048 lds
    buffer_load_dwordx4 v7, s[20:23], s59 offen offset:3072 lds
    s_waitcnt vmcnt(12)
    s_barrier
    s_add_u32 m0, s51, 0
    s_add_u32 s7, s4, 1
    s_and_b32 s7, s7, 3
    s_or_b32 s7, s7, 4
    s_mul_i32 s7, s7, s53
    s_add_u32 s59, s52, s7
    buffer_load_dwordx4 v4, s[20:23], s59 offen lds
    s_add_u32 m0, s51, 98304
    s_add_u32 s7, s4, 0
    s_and_b32 s7, s7, 3
    s_or_b32 s7, s7, 4
    s_lshl_b32 s7, s7, 7
    s_add_u32 s58, s56, s7
    buffer_load_dwordx4 v16, s[8:11], s58 offen lds
    s_add_u32 m0, s51, 0
    s_nop 0
    buffer_load_dwordx4 v5, s[20:23], s59 offen offset:1024 lds
    s_lshl_b32 s6, s46, 11
    s_add_u32 s6, s6, 131072
    v_add_u32 v88, s6, v3
    s_add_u32 m0, s51, 98304
    s_nop 0
    buffer_load_dwordx4 v17, s[8:11], s58 offen offset:1024 lds
    v_mov_b32 v112, 0x3f803f80
    v_mov_b32 v113, 0x3f803f80
    v_mov_b32 v114, 0x3f803f80
    v_mov_b32 v115, 0x3f803f80
    s_add_u32 m0, s51, 0
    s_nop 0
    buffer_load_dwordx4 v6, s[20:23], s59 offen offset:2048 lds
    v_and_b32 v89, 31, v1
    v_lshlrev_b32 v89, 3, v89
    v_cmp_gt_u32 vcc, 32, v1
    v_mov_b32 v90, 2147483632
    s_nop 0
    v_cndmask_b32 v89, v90, v89, vcc
    s_add_u32 m0, s51, 98304
    s_nop 0
    buffer_load_dwordx4 v18, s[8:11], s58 offen offset:2048 lds
    ds_read_b64_tr_b16 v[96:97], v88 offset:0
    ds_read_b64_tr_b16 v[98:99], v88 offset:256
    ds_read_b64_tr_b16 v[100:101], v88 offset:1024
    ds_read_b64_tr_b16 v[102:103], v88 offset:1280
    s_add_u32 m0, s51, 0
    s_nop 0
    buffer_load_dwordx4 v7, s[20:23], s59 offen offset:3072 lds
    s_waitcnt lgkmcnt(0)
    v_mfma_f32_32x32x16_bf16 v[52:67], v[112:115], v[96:99], 0
    v_mfma_f32_32x32x16_bf16 v[52:67], v[112:115], v[100:103], v[52:67]
    s_add_u32 m0, s51, 98304
    s_nop 0
    buffer_load_dwordx4 v19, s[8:11], s58 offen offset:3072 lds
    s_lshl_b32 s6, s48, 4
    s_add_u32 s6, s6, s47
    s_lshl_b32 s6, s6, 2
    s_add_u32 s6, s6, s46
    s_lshl_b32 s6, s6, 8
    s_add_u32 s71, s6, 786432
    s_nop 2
    v_mov_b32 v84, v52
    v_mov_b32 v85, v30
    buffer_store_dwordx2 v[84:85], v89, s[12:15], s71 offen sc1
    s_waitcnt vmcnt(14)
    s_waitcnt vmcnt(13)
    s_barrier
    s_add_u32 m0, s51, 16384
    s_add_u32 s7, s4, 2
    s_and_b32 s7, s7, 3
    s_or_b32 s7, s7, 4
    s_mul_i32 s7, s7, s53
    s_add_u32 s59, s52, s7
    buffer_load_dwordx4 v4, s[20:23], s59 offen lds
    s_add_u32 m0, s51, 114688
    s_add_u32 s7, s4, 1
    s_and_b32 s7, s7, 3
    s_or_b32 s7, s7, 4
    s_lshl_b32 s7, s7, 7
    s_add_u32 s58, s56, s7
    buffer_load_dwordx4 v16, s[8:11], s58 offen lds
    s_add_u32 m0, s51, 16384
    s_nop 0
    buffer_load_dwordx4 v5, s[20:23], s59 offen offset:1024 lds
    s_add_u32 m0, s51, 114688
    s_nop 0
    buffer_load_dwordx4 v17, s[8:11], s58 offen offset:1024 lds
    s_add_u32 m0, s51, 16384
    s_nop 0
    buffer_load_dwordx4 v6, s[20:23], s59 offen offset:2048 lds
    s_add_u32 m0, s51, 114688
    s_nop 0
    buffer_load_dwordx4 v18, s[8:11], s58 offen offset:2048 lds
    s_add_u32 m0, s51, 16384
    s_nop 0
    buffer_load_dwordx4 v7, s[20:23], s59 offen offset:3072 lds
    s_add_u32 m0, s51, 114688
    s_nop 0
    buffer_load_dwordx4 v19, s[8:11], s58 offen offset:3072 lds
    s_waitcnt vmcnt(17)
    s_waitcnt vmcnt(9)
    s_barrier
    s_add_u32 m0, s51, 32768
    s_add_u32 s7, s4, 3
    s_and_b32 s7, s7, 3
    s_or_b32 s7, s7, 4
    s_mul_i32 s7, s7, s53
    s_add_u32 s59, s52, s7
    buffer_load_dwordx4 v4, s[20:23], s59 offen lds
    s_add_u32 m0, s51, 81920
    s_add_u32 s7, s4, 2
    s_and_b32 s7, s7, 3
    s_or_b32 s7, s7, 4
    s_lshl_b32 s7, s7, 7
    s_add_u32 s58, s56, s7
    buffer_load_dwordx4 v16, s[8:11], s58 offen lds
    s_add_u32 m0, s51, 32768
    s_nop 0
    buffer_load_dwordx4 v5, s[20:23], s59 offen offset:1024 lds
    s_add_u32 m0, s51, 131072
    s_nop 0
    buffer_load_dwordx4 v36, s[24:27], s74 offen lds
    buffer_load_dwordx4 v37, s[24:27], s74 offen offset:1024 lds
    s_add_u32 m0, s51, 81920
    s_nop 0
    buffer_load_dwordx4 v17, s[8:11], s58 offen offset:1024 lds
    s_add_u32 m0, s51, 133120
    s_nop 0
    buffer_load_dwordx4 v12, s[28:31], s75 offen lds
    buffer_load_dwordx4 v13, s[28:31], s75 offen offset:1024 lds
    s_add_u32 m0, s51, 32768
    s_nop 0
    buffer_load_dwordx4 v6, s[20:23], s59 offen offset:2048 lds
    s_add_u32 m0, s51, 81920
    s_nop 0
    buffer_load_dwordx4 v18, s[8:11], s58 offen offset:2048 lds
    s_add_u32 m0, s51, 32768
    s_nop 0
    buffer_load_dwordx4 v7, s[20:23], s59 offen offset:3072 lds
    s_add_u32 m0, s51, 81920
    s_nop 0
    buffer_load_dwordx4 v19, s[8:11], s58 offen offset:3072 lds
    s_waitcnt vmcnt(12)
    s_barrier
    s_add_u32 m0, s51, 49152
    s_add_u32 s7, s4, 0
    s_and_b32 s7, s7, 3
    s_mul_i32 s7, s7, 229376
    s_add_u32 s59, s54, s7
    buffer_load_dwordx4 v8, s[24:27], s59 offen lds
    s_add_u32 m0, s51, 98304
    s_add_u32 s7, s4, 3
    s_and_b32 s7, s7, 3
    s_or_b32 s7, s7, 4
    s_lshl_b32 s7, s7, 7
    s_add_u32 s58, s56, s7
    buffer_load_dwordx4 v16, s[8:11], s58 offen lds
    s_add_u32 m0, s51, 49152
    s_nop 0
    buffer_load_dwordx4 v9, s[24:27], s59 offen offset:1024 lds
    v_and_b32 v92, 31, v1
    v_lshlrev_b32 v92, 3, v92
    v_lshrrev_b32 v93, 5, v1
    v_lshl_add_u32 v92, v93, 10, v92
    s_add_u32 m0, s51, 98304
    s_nop 0
    buffer_load_dwordx4 v17, s[8:11], s58 offen offset:1024 lds
    s_lshl_b32 s6, s48, 14
    s_lshl_b32 s7, s46, 8
    s_add_u32 s6, s6, s7
    s_add_u32 s68, s6, 786432
    s_add_u32 m0, s51, 49152
    s_nop 0
    buffer_load_dwordx4 v10, s[24:27], s59 offen offset:2048 lds
    s_add_u32 s69, s68, 0
    buffer_load_dwordx2 v[52:53], v92, s[12:15], s69 offen sc1
    s_add_u32 m0, s51, 98304
    s_nop 0
    buffer_load_dwordx4 v18, s[8:11], s58 offen offset:2048 lds
    s_add_u32 s69, s68, 2048
    buffer_load_dwordx2 v[54:55], v92, s[12:15], s69 offen sc1
    s_add_u32 m0, s51, 49152
    s_nop 0
    buffer_load_dwordx4 v11, s[24:27], s59 offen offset:3072 lds
    s_add_u32 s69, s68, 4096
    buffer_load_dwordx2 v[56:57], v92, s[12:15], s69 offen sc1
    s_add_u32 m0, s51, 98304
    s_nop 0
    buffer_load_dwordx4 v19, s[8:11], s58 offen offset:3072 lds
    s_add_u32 s69, s68, 6144
    buffer_load_dwordx2 v[58:59], v92, s[12:15], s69 offen sc1
    v_and_b32 v44, 31, v1
    v_lshlrev_b32 v45, 4, v44
    s_lshl_b32 s6, s47, 7
    s_lshl_b32 s7, s46, 5
    s_add_u32 s6, s6, s7
    s_lshl_b32 s72, s6, 4
    s_add_u32 s72, s72, 65536
    buffer_load_dwordx4 v[48:51], v45, s[12:15], s72 offen sc1
    s_waitcnt vmcnt(13)
    s_barrier
    s_add_u32 m0, s51, 65536
    s_add_u32 s7, s4, 1
    s_and_b32 s7, s7, 3
    s_mul_i32 s7, s7, 229376
    s_add_u32 s59, s54, s7
    buffer_load_dwordx4 v8, s[24:27], s59 offen lds
    s_add_u32 s69, s68, 8192
    buffer_load_dwordx2 v[60:61], v92, s[12:15], s69 offen sc1
    s_add_u32 s69, s68, 10240
    buffer_load_dwordx2 v[62:63], v92, s[12:15], s69 offen sc1
    buffer_load_dwordx4 v9, s[24:27], s59 offen offset:1024 lds
    s_add_u32 s69, s68, 12288
    buffer_load_dwordx2 v[64:65], v92, s[12:15], s69 offen sc1
    s_add_u32 s69, s68, 14336
    buffer_load_dwordx2 v[66:67], v92, s[12:15], s69 offen sc1
    buffer_load_dwordx4 v10, s[24:27], s59 offen offset:2048 lds
    buffer_load_dwordx4 v11, s[24:27], s59 offen offset:3072 lds
    s_waitcnt vmcnt(8)
    v_cmp_eq_u32 vcc, v50, v30
    v_cmp_eq_u32 s[64:65], v51, v31
    s_nop 0
    s_and_b64 vcc, vcc, s[64:65]
    s_cmp_eq_u64 vcc, -1
    s_cbranch_scc0 Lslow_13
Lback_14:
    v_sub_f32 v48, 0, v48
    v_lshlrev_b32 v44, 3, v44
    s_lshl_b32 s6, s46, 8
    s_add_u32 s6, s6, 151040
    v_add_u32 v44, s6, v44
    ds_write_b64 v44, v[48:49]
    s_barrier
    s_add_u32 m0, s51, 0
    s_add_u32 s7, s4, 2
    s_and_b32 s7, s7, 3
    s_mul_i32 s7, s7, 229376
    s_add_u32 s59, s54, s7
    buffer_load_dwordx4 v8, s[24:27], s59 offen lds
    s_lshl_b32 s6, s46, 12
    s_add_u32 s6, s6, 131072
    v_add_u32 v88, s6, v3
    buffer_load_dwordx4 v9, s[24:27], s59 offen offset:1024 lds
    v_mov_b32 v112, 0x3f803f80
    v_mov_b32 v113, 0x3f803f80
    v_mov_b32 v114, 0x3f803f80
    v_mov_b32 v115, 0x3f803f80
    v_and_b32 v89, 31, v1
    v_lshlrev_b32 v89, 4, v89
    v_cmp_gt_u32 vcc, 32, v1
    v_mov_b32 v90, 2147483632
    s_nop 0
    v_cndmask_b32 v89, v90, v89, vcc
    buffer_load_dwordx4 v10, s[24:27], s59 offen offset:2048 lds
    ds_read_b64_tr_b16 v[96:97], v88 offset:0
    ds_read_b64_tr_b16 v[98:99], v88 offset:256
    ds_read_b64_tr_b16 v[100:101], v88 offset:1024
    ds_read_b64_tr_b16 v[102:103], v88 offset:1280
    ds_read_b64_tr_b16 v[104:105], v88 offset:2048
    ds_read_b64_tr_b16 v[106:107], v88 offset:2304
    ds_read_b64_tr_b16 v[108:109], v88 offset:3072
    ds_read_b64_tr_b16 v[110:111], v88 offset:3328
    buffer_load_dwordx4 v11, s[24:27], s59 offen offset:3072 lds
    s_waitcnt vmcnt(6)
    v_cmp_eq_u32 vcc, v53, v30
    v_cmp_eq_u32 s[64:65], v55, v30
    s_nop 0
    s_and_b64 vcc, vcc, s[64:65]
    v_cmp_eq_u32 s[64:65], v57, v30
    s_nop 0
    s_and_b64 vcc, vcc, s[64:65]
    v_cmp_eq_u32 s[64:65], v59, v30
    s_nop 0
    s_and_b64 vcc, vcc, s[64:65]
    v_cmp_eq_u32 s[64:65], v61, v30
    s_nop 0
    s_and_b64 vcc, vcc, s[64:65]
    v_cmp_eq_u32 s[64:65], v63, v30
    s_nop 0
    s_and_b64 vcc, vcc, s[64:65]
    v_cmp_eq_u32 s[64:65], v65, v30
    s_nop 0
    s_and_b64 vcc, vcc, s[64:65]
    v_cmp_eq_u32 s[64:65], v67, v30
    s_nop 0
    s_and_b64 vcc, vcc, s[64:65]
    s_cmp_eq_u64 vcc, -1
    s_cbranch_scc0 Lslow_15
Lback_16:
    v_add_f32 v52, v52, v54
    v_add_f32 v52, v52, v56
    v_add_f32 v52, v52, v58
    v_add_f32 v52, v52, v60
    v_add_f32 v52, v52, v62
    v_add_f32 v52, v52, v64
    v_add_f32 v52, v52, v66
    v_mov_b32 v56, v52
    s_nop 1
    v_permlane32_swap_b32 v52, v56
    v_add_f32 v52, v52, v56
    v_cvt_pk_bf16_f32 v56, v52, v52
    v_lshlrev_b32 v56, 16, v56
    v_sub_f32 v56, v52, v56
    v_cvt_pk_bf16_f32 v52, v52, v56
    s_lshl_b32 s6, s46, 7
    v_add_u32 v93, s6, v25
    ds_write_b32 v93, v52
    s_waitcnt lgkmcnt(0)
    s_barrier
    s_add_u32 m0, s51, 16384
    s_add_u32 s7, s4, 3
    s_and_b32 s7, s7, 3
    s_mul_i32 s7, s7, 229376
    s_add_u32 s59, s54, s7
    buffer_load_dwordx4 v8, s[24:27], s59 offen lds
    v_mfma_f32_32x32x16_bf16 v[52:67], v[112:115], v[96:99], 0
    v_mfma_f32_32x32x16_bf16 v[52:67], v[112:115], v[100:103], v[52:67]
    v_mfma_f32_32x32x16_bf16 v[68:83], v[112:115], v[104:107], 0
    v_mfma_f32_32x32x16_bf16 v[68:83], v[112:115], v[108:111], v[68:83]
    s_lshl_b32 s6, s48, 4
    s_add_u32 s6, s6, s47
    s_lshl_b32 s6, s6, 2
    s_add_u32 s6, s6, s46
    s_lshl_b32 s6, s6, 9
    s_add_u32 s71, s6, 262144
    buffer_load_dwordx4 v9, s[24:27], s59 offen offset:1024 lds
    s_bfe_u32 s6, s5, 524312
    s_lshl_b32 s6, s6, 16
    s_lshl_b32 s7, s81, 7
    s_add_u32 s75, s6, s7
    buffer_load_dwordx4 a[0:3], v20, s[32:35], s75 offen
    buffer_load_dwordx4 a[4:7], v21, s[32:35], s75 offen offset:1024
    buffer_load_dwordx4 a[8:11], v22, s[32:35], s75 offen offset:2048
    buffer_load_dwordx4 a[12:15], v23, s[32:35], s75 offen offset:3072
    s_add_u32 s75, s75, 32768
    buffer_load_dwordx4 a[16:19], v20, s[32:35], s75 offen
    buffer_load_dwordx4 a[20:23], v21, s[32:35], s75 offen offset:1024
    buffer_load_dwordx4 v10, s[24:27], s59 offen offset:2048 lds
    buffer_load_dwordx4 a[24:27], v22, s[32:35], s75 offen offset:2048
    buffer_load_dwordx4 a[28:31], v23, s[32:35], s75 offen offset:3072
    s_bfe_u32 s6, s3, 524288
    s_lshl_b32 s6, s6, 16
    s_lshl_b32 s7, s81, 7
    s_add_u32 s75, s6, s7
    buffer_load_dwordx4 a[32:35], v20, s[32:35], s75 offen
    buffer_load_dwordx4 a[36:39], v21, s[32:35], s75 offen offset:1024
    buffer_load_dwordx4 a[40:43], v22, s[32:35], s75 offen offset:2048
    buffer_load_dwordx4 a[44:47], v23, s[32:35], s75 offen offset:3072
    s_add_u32 s75, s75, 32768
    buffer_load_dwordx4 a[48:51], v20, s[32:35], s75 offen
    buffer_load_dwordx4 v11, s[24:27], s59 offen offset:3072 lds
    buffer_load_dwordx4 a[52:55], v21, s[32:35], s75 offen offset:1024
    buffer_load_dwordx4 a[56:59], v22, s[32:35], s75 offen offset:2048
    buffer_load_dwordx4 a[60:63], v23, s[32:35], s75 offen offset:3072
    s_waitcnt vmcnt(24)
    s_barrier
    s_add_u32 m0, s51, 32768
    s_add_u32 s7, s4, 0
    s_and_b32 s7, s7, 3
    s_or_b32 s7, s7, 4
    s_mul_i32 s7, s7, 229376
    s_add_u32 s59, s54, s7
    buffer_load_dwordx4 v8, s[24:27], s59 offen lds
    v_mov_b32 v84, v52
    v_mov_b32 v85, v68
    v_mov_b32 v86, v30
    v_mov_b32 v87, v30
    buffer_store_dwordx4 v[84:87], v89, s[12:15], s71 offen sc1
    buffer_load_dwordx4 v9, s[24:27], s59 offen offset:1024 lds
    buffer_load_dwordx4 v10, s[24:27], s59 offen offset:2048 lds
    buffer_load_dwordx4 v11, s[24:27], s59 offen offset:3072 lds
    s_waitcnt vmcnt(25)
    s_barrier
    buffer_store_dwordx2 v[30:31], v26, s[12:15], s77 offen offset:0 sc1
    s_add_u32 m0, s51, 49152
    s_add_u32 s7, s4, 1
    s_and_b32 s7, s7, 3
    s_or_b32 s7, s7, 4
    s_mul_i32 s7, s7, 229376
    s_add_u32 s59, s54, s7
    buffer_load_dwordx4 v8, s[24:27], s59 offen lds
    buffer_load_dwordx4 v9, s[24:27], s59 offen offset:1024 lds
    buffer_load_dwordx4 v10, s[24:27], s59 offen offset:2048 lds
    buffer_load_dwordx4 v11, s[24:27], s59 offen offset:3072 lds
    s_waitcnt vmcnt(13)
    s_barrier
    s_add_u32 m0, s51, 65536
    s_add_u32 s7, s4, 2
    s_and_b32 s7, s7, 3
    s_or_b32 s7, s7, 4
    s_mul_i32 s7, s7, 229376
    s_add_u32 s59, s54, s7
    buffer_load_dwordx4 v8, s[24:27], s59 offen lds
    buffer_load_dwordx4 v9, s[24:27], s59 offen offset:1024 lds
    buffer_load_dwordx4 v10, s[24:27], s59 offen offset:2048 lds
    buffer_load_dwordx4 v11, s[24:27], s59 offen offset:3072 lds
    s_waitcnt vmcnt(9)
    s_barrier
    s_add_u32 m0, s51, 0
    s_add_u32 s7, s4, 3
    s_and_b32 s7, s7, 3
    s_or_b32 s7, s7, 4
    s_mul_i32 s7, s7, 229376
    s_add_u32 s59, s54, s7
    buffer_load_dwordx4 v8, s[24:27], s59 offen lds
    v_and_b32 v92, 31, v1
    v_lshlrev_b32 v92, 4, v92
    v_lshrrev_b32 v93, 5, v1
    v_lshl_add_u32 v92, v93, 11, v92
    buffer_load_dwordx4 v9, s[24:27], s59 offen offset:1024 lds
    s_lshl_b32 s6, s48, 15
    s_lshl_b32 s7, s46, 9
    s_add_u32 s6, s6, s7
    s_add_u32 s68, s6, 262144
    s_add_u32 s69, s68, 0
    buffer_load_dwordx4 v[52:55], v92, s[12:15], s69 offen sc1
    s_add_u32 s69, s68, 4096
    buffer_load_dwordx4 v[56:59], v92, s[12:15], s69 offen sc1
    buffer_load_dwordx4 v10, s[24:27], s59 offen offset:2048 lds
    s_add_u32 s69, s68, 8192
    buffer_load_dwordx4 v[60:63], v92, s[12:15], s69 offen sc1
    s_add_u32 s69, s68, 12288
    buffer_load_dwordx4 v[64:67], v92, s[12:15], s69 offen sc1
    s_add_u32 s69, s68, 16384
    buffer_load_dwordx4 v[68:71], v92, s[12:15], s69 offen sc1
    buffer_load_dwordx4 v11, s[24:27], s59 offen offset:3072 lds
    s_bfe_u32 s6, s5, 524288
    s_lshl_b32 s6, s6, 16
    s_lshl_b32 s7, s81, 7
    s_add_u32 s74, s6, s7
    s_waitcnt vmcnt(13)
    s_barrier
    s_add_u32 m0, s51, 16384
    s_and_b32 s7, s46, 1
    s_add_u32 s7, s7, s4
    s_add_u32 s7, s7, 0
    s_and_b32 s7, s7, 3
    s_mul_i32 s7, s7, s55
    s_add_u32 s59, s44, s7
    buffer_load_dwordx4 v12, s[28:31], s59 offen lds
    s_add_u32 s69, s68, 20480
    buffer_load_dwordx4 v[72:75], v92, s[12:15], s69 offen sc1
    s_add_u32 s69, s68, 24576
    buffer_load_dwordx4 v[76:79], v92, s[12:15], s69 offen sc1
    buffer_load_dwordx4 v13, s[28:31], s59 offen offset:1024 lds
    s_add_u32 s69, s68, 28672
    buffer_load_dwordx4 v[80:83], v92, s[12:15], s69 offen sc1
    s_add_u32 m0, s57, 81920
    s_nop 0
    buffer_load_dwordx4 v20, s[32:35], s74 offen lds
    buffer_load_dwordx4 v21, s[32:35], s74 offen offset:1024 lds
    s_add_u32 m0, s51, 16384
    s_nop 0
    buffer_load_dwordx4 v14, s[28:31], s59 offen offset:2048 lds
    buffer_load_dwordx4 v15, s[28:31], s59 offen offset:3072 lds
    s_waitcnt vmcnt(18)
    s_barrier
    s_add_u32 m0, s51, 32768
    s_and_b32 s7, s46, 1
    s_add_u32 s7, s7, s4
    s_add_u32 s7, s7, 2
    s_and_b32 s7, s7, 3
    s_mul_i32 s7, s7, s55
    s_add_u32 s59, s44, s7
    buffer_load_dwordx4 v12, s[28:31], s59 offen lds
    s_add_u32 m0, s57, 81920
    s_nop 0
    buffer_load_dwordx4 v22, s[32:35], s74 offen offset:2048 lds
    buffer_load_dwordx4 v23, s[32:35], s74 offen offset:3072 lds
    s_add_u32 m0, s51, 32768
    s_nop 0
    buffer_load_dwordx4 v13, s[28:31], s59 offen offset:1024 lds
    s_add_u32 m0, s57, 86016
    s_add_u32 s74, s74, 32768
    buffer_load_dwordx4 v20, s[32:35], s74 offen lds
    buffer_load_dwordx4 v21, s[32:35], s74 offen offset:1024 lds
    buffer_load_dwordx4 v22, s[32:35], s74 offen offset:2048 lds
    buffer_load_dwordx4 v23, s[32:35], s74 offen offset:3072 lds
    s_add_u32 m0, s51, 32768
    s_nop 0
    buffer_load_dwordx4 v14, s[28:31], s59 offen offset:2048 lds
    s_lshl_b32 s6, s49, 2
    s_add_u32 s6, s6, s46
    s_lshl_b32 s7, s6, 7
    s_add_u32 s71, s7, 11075584
    s_lshl_b32 s7, s6, 14
    s_add_u32 s73, s7, 10485760
    s_lshl_b32 s7, s6, 10
    s_add_u32 s76, s7, 11010048
    v_and_b32 v40, 15, v1
    v_lshlrev_b32 v40, 3, v40
    buffer_load_dwordx2 v[42:43], v40, s[12:15], s71 offen sc1
    buffer_load_dwordx4 v15, s[28:31], s59 offen offset:3072 lds
    s_waitcnt vmcnt(15)
    v_cmp_eq_u32 vcc, v55, v30
    v_cmp_eq_u32 s[64:65], v59, v30
    s_nop 0
    s_and_b64 vcc, vcc, s[64:65]
    v_cmp_eq_u32 s[64:65], v63, v30
    s_nop 0
    s_and_b64 vcc, vcc, s[64:65]
    v_cmp_eq_u32 s[64:65], v67, v30
    s_nop 0
    s_and_b64 vcc, vcc, s[64:65]
    v_cmp_eq_u32 s[64:65], v71, v30
    s_nop 0
    s_and_b64 vcc, vcc, s[64:65]
    v_cmp_eq_u32 s[64:65], v75, v30
    s_nop 0
    s_and_b64 vcc, vcc, s[64:65]
    v_cmp_eq_u32 s[64:65], v79, v30
    s_nop 0
    s_and_b64 vcc, vcc, s[64:65]
    v_cmp_eq_u32 s[64:65], v83, v30
    s_nop 0
    s_and_b64 vcc, vcc, s[64:65]
    s_cmp_eq_u64 vcc, -1
    s_cbranch_scc0 Lslow_17
Lback_18:
    v_add_f32 v52, v52, v56
    v_add_f32 v53, v53, v57
    v_add_f32 v52, v52, v60
    v_add_f32 v53, v53, v61
    v_add_f32 v52, v52, v64
    v_add_f32 v53, v53, v65
    v_add_f32 v52, v52, v68
    v_add_f32 v53, v53, v69
    v_add_f32 v52, v52, v72
    v_add_f32 v53, v53, v73
    v_add_f32 v52, v52, v76
    v_add_f32 v53, v53, v77
    v_add_f32 v52, v52, v80
    v_add_f32 v53, v53, v81
    v_mov_b32 v56, v52
    v_mov_b32 v57, v53
    s_nop 0
    v_permlane32_swap_b32 v52, v56
    v_permlane32_swap_b32 v53, v57
    v_add_f32 v52, v52, v56
    v_add_f32 v53, v53, v57
    s_barrier
    s_add_u32 m0, s51, 49152
    s_and_b32 s7, s46, 1
    s_add_u32 s7, s7, s4
    s_add_u32 s7, s7, 0
    s_and_b32 s7, s7, 3
    s_or_b32 s7, s7, 4
    s_mul_i32 s7, s7, s55
    s_add_u32 s59, s44, s7
    buffer_load_dwordx4 v12, s[28:31], s59 offen lds
    v_cvt_pk_bf16_f32 v56, v52, v52
    v_cvt_pk_bf16_f32 v57, v53, v53
    v_lshlrev_b32 v56, 16, v56
    v_lshlrev_b32 v57, 16, v57
    v_sub_f32 v56, v52, v56
    v_sub_f32 v57, v53, v57
    v_cvt_pk_bf16_f32 v52, v52, v56
    v_cvt_pk_bf16_f32 v53, v53, v57
    buffer_load_dwordx4 v13, s[28:31], s59 offen offset:1024 lds
    s_lshl_b32 s6, s46, 7
    v_add_u32 v93, s6, v25
    ds_write_b32 v93, v52 offset:512
    s_lshr_b32 s6, s46, 1
    s_lshl_b32 s6, s6, 7
    v_add_u32 v93, s6, v25
    ds_write_b32 v93, v53 offset:1024
    s_waitcnt vmcnt(3)
    v_cmp_eq_u32 vcc, v42, v30
    v_cmp_eq_u32 s[64:65], v43, v31
    s_nop 0
    s_and_b64 vcc, vcc, s[64:65]
    s_cmp_eq_u64 vcc, -1
    s_cbranch_scc0 Lslow_19
Lback_20:
    buffer_load_dwordx4 v[116:119], v2, s[12:15], s76 offen sc1
    buffer_load_dwordx4 v14, s[28:31], s59 offen offset:2048 lds
    buffer_load_dwordx4 v[52:55], v2, s[12:15], s73 offen offset:0 sc1
    buffer_load_dwordx4 v[56:59], v2, s[12:15], s73 offen offset:1024 sc1
    buffer_load_dwordx4 v[60:63], v2, s[12:15], s73 offen offset:2048 sc1
    buffer_load_dwordx4 v[64:67], v2, s[12:15], s73 offen offset:3072 sc1
    buffer_load_dwordx4 v15, s[28:31], s59 offen offset:3072 lds
    s_waitcnt lgkmcnt(0)
    s_barrier
    v_bfe_u32 v27, v1, 1, 3
    v_lshlrev_b32 v27, 2, v27
    v_and_b32 v32, 1, v1
    v_add_u32 v27, v27, v32
    v_add_u32 v27, 2, v27
    v_lshlrev_b32 v27, 3, v27
    s_mul_i32 s72, s80, 768
    s_add_u32 s72, s72, 8192
    buffer_load_dwordx2 v[32:33], v27, s[12:15], s72 offen sc1
    s_add_u32 m0, s51, 65536
    s_and_b32 s7, s46, 1
    s_add_u32 s7, s7, s4
    s_add_u32 s7, s7, 2
    s_and_b32 s7, s7, 3
    s_or_b32 s7, s7, 4
    s_mul_i32 s7, s7, s55
    s_add_u32 s59, s44, s7
    buffer_load_dwordx4 v12, s[28:31], s59 offen lds
    s_add_u32 s73, s73, 4096
    buffer_load_dwordx4 v[68:71], v2, s[12:15], s73 offen offset:0 sc1
    buffer_load_dwordx4 v[72:75], v2, s[12:15], s73 offen offset:1024 sc1
    buffer_load_dwordx4 v[76:79], v2, s[12:15], s73 offen offset:2048 sc1
    buffer_load_dwordx4 v[80:83], v2, s[12:15], s73 offen offset:3072 sc1
    s_add_u32 s73, s73, 4096
    buffer_load_dwordx4 v[84:87], v2, s[12:15], s73 offen offset:0 sc1
    buffer_load_dwordx4 v13, s[28:31], s59 offen offset:1024 lds
    buffer_load_dwordx4 v[88:91], v2, s[12:15], s73 offen offset:1024 sc1
    buffer_load_dwordx4 v[92:95], v2, s[12:15], s73 offen offset:2048 sc1
    buffer_load_dwordx4 v[96:99], v2, s[12:15], s73 offen offset:3072 sc1
    s_add_u32 s73, s73, 4096
    buffer_load_dwordx4 v[100:103], v2, s[12:15], s73 offen offset:0 sc1
    buffer_load_dwordx4 v[104:107], v2, s[12:15], s73 offen offset:1024 sc1
    buffer_load_dwordx4 v[108:111], v2, s[12:15], s73 offen offset:2048 sc1
    buffer_load_dwordx4 v[112:115], v2, s[12:15], s73 offen offset:3072 sc1
    s_bfe_u32 s6, s3, 524296
    s_lshl_b32 s6, s6, 16
    s_lshl_b32 s7, s81, 7
    s_add_u32 s75, s6, s7
    buffer_load_dwordx4 v14, s[28:31], s59 offen offset:2048 lds
    buffer_load_dwordx4 a[64:67], v20, s[32:35], s75 offen
    buffer_load_dwordx4 a[68:71], v21, s[32:35], s75 offen offset:1024
    buffer_load_dwordx4 a[72:75], v22, s[32:35], s75 offen offset:2048
    buffer_load_dwordx4 a[76:79], v23, s[32:35], s75 offen offset:3072
    s_add_u32 s75, s75, 32768
    buffer_load_dwordx4 a[80:83], v20, s[32:35], s75 offen
    buffer_load_dwordx4 a[84:87], v21, s[32:35], s75 offen offset:1024
    buffer_load_dwordx4 a[88:91], v22, s[32:35], s75 offen offset:2048
    buffer_load_dwordx4 a[92:95], v23, s[32:35], s75 offen offset:3072
    s_bfe_u32 s6, s3, 524304
    s_cmp_lt_u32 s6, 28
    s_cselect_b32 s20, s32, s36
    s_cselect_b32 s21, s33, s37
    s_cselect_b32 s22, s34, s38
    s_cselect_b32 s7, 0, 28
    s_sub_u32 s6, s6, s7
    s_lshl_b32 s6, s6, 16
    s_lshl_b32 s7, s81, 7
    s_add_u32 s75, s6, s7
    buffer_load_dwordx4 v15, s[28:31], s59 offen offset:3072 lds
    s_waitcnt vmcnt(34)
    s_barrier
    s_waitcnt vmcnt(31)
    v_add_f32_dpp v116, v116, v116 row_shr:4 row_mask:0xf bank_mask:0xf bound_ctrl:0
    v_add_f32_dpp v117, v117, v117 row_shr:4 row_mask:0xf bank_mask:0xf bound_ctrl:0
    v_add_f32_dpp v118, v118, v118 row_shr:4 row_mask:0xf bank_mask:0xf bound_ctrl:0
    v_add_f32_dpp v119, v119, v119 row_shr:4 row_mask:0xf bank_mask:0xf bound_ctrl:0
    v_add_f32_dpp v116, v116, v116 row_shr:8 row_mask:0xf bank_mask:0xf bound_ctrl:0
    v_add_f32_dpp v117, v117, v117 row_shr:8 row_mask:0xf bank_mask:0xf bound_ctrl:0
    v_add_f32_dpp v118, v118, v118 row_shr:8 row_mask:0xf bank_mask:0xf bound_ctrl:0
    v_add_f32_dpp v119, v119, v119 row_shr:8 row_mask:0xf bank_mask:0xf bound_ctrl:0
    v_mov_b32 v120, v116
    v_mov_b32 v121, v117
    v_mov_b32 v122, v118
    v_mov_b32 v123, v119
    v_permlane16_swap_b32 v116, v120
    v_permlane16_swap_b32 v117, v121
    v_permlane16_swap_b32 v118, v122
    v_permlane16_swap_b32 v119, v123
    v_add_f32 v116, v116, v120
    v_add_f32 v117, v117, v121
    v_add_f32 v118, v118, v122
    v_add_f32 v119, v119, v123
    v_mov_b32 v120, v116
    v_mov_b32 v121, v117
    v_mov_b32 v122, v118
    v_mov_b32 v123, v119
    v_permlane32_swap_b32 v116, v120
    v_permlane32_swap_b32 v117, v121
    v_permlane32_swap_b32 v118, v122
    v_permlane32_swap_b32 v119, v123
    v_add_f32 v116, v116, v120
    v_add_f32 v117, v117, v121
    v_add_f32 v118, v118, v122
    v_add_f32 v119, v119, v123
    s_waitcnt vmcnt(28)
    v_pk_add_f32 v[52:53], v[52:53], v[56:57]
    v_pk_add_f32 v[54:55], v[54:55], v[58:59]
    s_waitcnt vmcnt(27)
    v_pk_add_f32 v[52:53], v[52:53], v[60:61]
    v_pk_add_f32 v[54:55], v[54:55], v[62:63]
    s_waitcnt vmcnt(26)
    v_pk_add_f32 v[52:53], v[52:53], v[64:65]
    v_pk_add_f32 v[54:55], v[54:55], v[66:67]
    s_waitcnt vmcnt(22)
    v_pk_add_f32 v[52:53], v[52:53], v[68:69]
    v_pk_add_f32 v[54:55], v[54:55], v[70:71]
    s_waitcnt vmcnt(21)
    v_pk_add_f32 v[52:53], v[52:53], v[72:73]
    v_pk_add_f32 v[54:55], v[54:55], v[74:75]
    s_waitcnt vmcnt(20)
    v_pk_add_f32 v[52:53], v[52:53], v[76:77]
    v_pk_add_f32 v[54:55], v[54:55], v[78:79]
    s_waitcnt vmcnt(19)
    v_pk_add_f32 v[52:53], v[52:53], v[80:81]
    v_pk_add_f32 v[54:55], v[54:55], v[82:83]
    s_waitcnt vmcnt(18)
    v_pk_add_f32 v[52:53], v[52:53], v[84:85]
    v_pk_add_f32 v[54:55], v[54:55], v[86:87]
    s_waitcnt vmcnt(16)
    v_pk_add_f32 v[52:53], v[52:53], v[88:89]
    v_pk_add_f32 v[54:55], v[54:55], v[90:91]
    s_waitcnt vmcnt(15)
    v_pk_add_f32 v[52:53], v[52:53], v[92:93]
    v_pk_add_f32 v[54:55], v[54:55], v[94:95]
    s_waitcnt vmcnt(14)
    v_pk_add_f32 v[52:53], v[52:53], v[96:97]
    v_pk_add_f32 v[54:55], v[54:55], v[98:99]
    s_waitcnt vmcnt(13)
    v_pk_add_f32 v[52:53], v[52:53], v[100:101]
    v_pk_add_f32 v[54:55], v[54:55], v[102:103]
    s_waitcnt vmcnt(12)
    v_pk_add_f32 v[52:53], v[52:53], v[104:105]
    v_pk_add_f32 v[54:55], v[54:55], v[106:107]
    s_waitcnt vmcnt(11)
    v_pk_add_f32 v[52:53], v[52:53], v[108:109]
    v_pk_add_f32 v[54:55], v[54:55], v[110:111]
    s_waitcnt vmcnt(10)
    v_pk_add_f32 v[52:53], v[52:53], v[112:113]
    v_pk_add_f32 v[54:55], v[54:55], v[114:115]
    s_mul_i32 s6, s46, 1280
    s_add_u32 s6, s6, 156672
    v_lshrrev_b32 v40, 4, v1
    v_lshlrev_b32 v40, 8, v40
    v_and_b32 v41, 15, v1
    v_lshl_add_u32 v40, v41, 2, v40
    v_add_u32 v40, s6, v40
    ds_write_b32 v40, v52 offset:0
    ds_write_b32 v40, v53 offset:64
    ds_write_b32 v40, v54 offset:128
    ds_write_b32 v40, v55 offset:192
    v_and_b32 v41, 3, v1
    v_lshlrev_b32 v41, 4, v41
    v_add_u32 v41, s6, v41
    v_add_u32 v41, 1024, v41
    v_and_b32 v42, 15, v1
    v_cmp_le_u32 vcc, 12, v42
    v_mov_b32 v43, 161792
    s_nop 0
    v_cndmask_b32 v41, v43, v41, vcc
    ds_write_b128 v41, v[116:119]
    buffer_load_dwordx4 a[96:99], v20, s[20:23], s75 offen
    buffer_load_dwordx4 a[100:103], v21, s[20:23], s75 offen offset:1024
    buffer_load_dwordx4 a[104:107], v22, s[20:23], s75 offen offset:2048
    buffer_load_dwordx4 a[108:111], v23, s[20:23], s75 offen offset:3072
    s_add_u32 s75, s75, 32768
    buffer_load_dwordx4 a[112:115], v20, s[20:23], s75 offen
    buffer_load_dwordx4 a[116:119], v21, s[20:23], s75 offen offset:1024
    buffer_load_dwordx4 a[120:123], v22, s[20:23], s75 offen offset:2048
    buffer_load_dwordx4 a[124:127], v23, s[20:23], s75 offen offset:3072
    s_mul_i32 s6, s46, 1280
    s_add_u32 s6, s6, 156672
    v_and_b32 v41, 31, v1
    v_min_u32 v41, 16, v41
    v_lshl_add_u32 v41, v41, 6, v24
    v_add_u32 v41, s6, v41
    s_waitcnt lgkmcnt(0)
    ds_read_b128 v[52:55], v41
    ds_read_b128 v[56:59], v41 offset:32
    v_cmp_eq_u32 vcc, v32, v30
    v_cmp_eq_u32 s[64:65], v33, v31
    s_nop 0
    s_and_b64 vcc, vcc, s[64:65]
    s_cmp_eq_u64 vcc, -1
    s_cbranch_scc0 Lslow_21
Lback_22:
    s_barrier
    buffer_store_dwordx2 v[30:31], v26, s[12:15], s77 offen offset:256 sc1
    s_bfe_u32 s6, s5, 524296
    s_lshl_b32 s6, s6, 16
    s_lshl_b32 s7, s81, 7
    s_add_u32 s74, s6, s7
    s_add_u32 m0, s57, 0
    s_nop 0
    buffer_load_dwordx4 v20, s[32:35], s74 offen lds
    buffer_load_dwordx4 v21, s[32:35], s74 offen offset:1024 lds
    buffer_load_dwordx4 v22, s[32:35], s74 offen offset:2048 lds
    buffer_load_dwordx4 v23, s[32:35], s74 offen offset:3072 lds
    s_add_u32 m0, s57, 4096
    s_add_u32 s74, s74, 32768
    buffer_load_dwordx4 v20, s[32:35], s74 offen lds
    s_waitcnt lgkmcnt(0)
    v_cvt_pk_bf16_f32 v60, v52, v53
    v_cvt_pk_bf16_f32 v61, v54, v55
    v_cvt_pk_bf16_f32 v62, v56, v57
    v_cvt_pk_bf16_f32 v63, v58, v59
    s_lshl_b32 s6, s46, 10
    s_add_u32 s6, s6, 152576
    v_add_u32 v41, s6, v2
    ds_write_b128 v41, v[60:63]
    buffer_load_dwordx4 v21, s[32:35], s74 offen offset:1024 lds
    buffer_load_dwordx4 v22, s[32:35], s74 offen offset:2048 lds
    buffer_load_dwordx4 v23, s[32:35], s74 offen offset:3072 lds
    s_waitcnt vmcnt(17)
    s_barrier
    s_waitcnt lgkmcnt(0)
    s_barrier
    s_bfe_u32 s6, s5, 524304
    s_lshl_b32 s6, s6, 16
    s_lshl_b32 s7, s81, 7
    s_add_u32 s74, s6, s7
    s_add_u32 m0, s57, 32768
    s_nop 0
    buffer_load_dwordx4 v20, s[32:35], s74 offen lds
    buffer_load_dwordx4 v21, s[32:35], s74 offen offset:1024 lds
    buffer_load_dwordx4 v22, s[32:35], s74 offen offset:2048 lds
    buffer_load_dwordx4 v23, s[32:35], s74 offen offset:3072 lds
    s_add_u32 m0, s57, 36864
    s_add_u32 s74, s74, 32768
    buffer_load_dwordx4 v20, s[32:35], s74 offen lds
    buffer_load_dwordx4 v21, s[32:35], s74 offen offset:1024 lds
    buffer_load_dwordx4 v22, s[32:35], s74 offen offset:2048 lds
    buffer_load_dwordx4 v23, s[32:35], s74 offen offset:3072 lds
    s_barrier
    s_add_u32 s6, s57, 114688
    v_add_u32 v40, s6, v2
    ds_write_b128 v40, a[0:3] offset:0
    ds_write_b128 v40, a[4:7] offset:1024
    ds_write_b128 v40, a[8:11] offset:2048
    ds_write_b128 v40, a[12:15] offset:3072
    ds_write_b128 v40, a[16:19] offset:4096
    ds_write_b128 v40, a[20:23] offset:5120
    ds_write_b128 v40, a[24:27] offset:6144
    ds_write_b128 v40, a[28:31] offset:7168
    v_and_b32 v27, 31, v1
    v_lshlrev_b32 v27, 3, v27
    s_mul_i32 s72, s80, 768
    s_add_u32 s72, s72, 8448
    buffer_load_dwordx2 v[32:33], v27, s[12:15], s72 offen sc1
    s_waitcnt vmcnt(0)
    v_cmp_eq_u32 vcc, v32, v30
    v_cmp_eq_u32 s[64:65], v33, v31
    s_nop 0
    s_and_b64 vcc, vcc, s[64:65]
    s_cmp_eq_u64 vcc, -1
    s_cbranch_scc0 Lslow_23
Lback_24:
    s_barrier
    s_barrier
    buffer_store_dwordx2 v[30:31], v26, s[12:15], s77 offen offset:512 sc1
    s_add_u32 s6, s57, 81920
    v_add_u32 v40, s6, v2
    ds_write_b128 v40, a[32:35] offset:0
    ds_write_b128 v40, a[36:39] offset:1024
    ds_write_b128 v40, a[40:43] offset:2048
    ds_write_b128 v40, a[44:47] offset:3072
    ds_write_b128 v40, a[48:51] offset:4096
    ds_write_b128 v40, a[52:55] offset:5120
    ds_write_b128 v40, a[56:59] offset:6144
    ds_write_b128 v40, a[60:63] offset:7168
    s_barrier
    s_add_u32 s6, s57, 0
    v_add_u32 v40, s6, v2
    ds_write_b128 v40, a[64:67] offset:0
    ds_write_b128 v40, a[68:71] offset:1024
    ds_write_b128 v40, a[72:75] offset:2048
    ds_write_b128 v40, a[76:79] offset:3072
    ds_write_b128 v40, a[80:83] offset:4096
    ds_write_b128 v40, a[84:87] offset:5120
    ds_write_b128 v40, a[88:91] offset:6144
    ds_write_b128 v40, a[92:95] offset:7168
    s_waitcnt lgkmcnt(15)
    s_barrier
    s_add_u32 s6, s57, 32768
    v_add_u32 v40, s6, v2
    ds_write_b128 v40, a[96:99] offset:0
    ds_write_b128 v40, a[100:103] offset:1024
    ds_write_b128 v40, a[104:107] offset:2048
    ds_write_b128 v40, a[108:111] offset:3072
    ds_write_b128 v40, a[112:115] offset:4096
    ds_write_b128 v40, a[116:119] offset:5120
    ds_write_b128 v40, a[120:123] offset:6144
    ds_write_b128 v40, a[124:127] offset:7168
    s_waitcnt lgkmcnt(15)
    s_barrier
    v_and_b32 v27, 31, v1
    v_lshlrev_b32 v27, 3, v27
    s_mul_i32 s72, s80, 768
    s_add_u32 s72, s72, 8704
    buffer_load_dwordx2 v[32:33], v27, s[12:15], s72 offen sc1
    s_bfe_u32 s6, s3, 524312
    s_cmp_lt_u32 s6, 28
    s_cselect_b32 s20, s32, s36
    s_cselect_b32 s21, s33, s37
    s_cselect_b32 s22, s34, s38
    s_cselect_b32 s7, 0, 28
    s_sub_u32 s6, s6, s7
    s_lshl_b32 s6, s6, 16
    s_lshl_b32 s7, s81, 7
    s_add_u32 s74, s6, s7
    s_add_u32 m0, s57, 114688
    s_nop 0
    buffer_load_dwordx4 v20, s[20:23], s74 offen lds
    buffer_load_dwordx4 v21, s[20:23], s74 offen offset:1024 lds
    buffer_load_dwordx4 v22, s[20:23], s74 offen offset:2048 lds
    buffer_load_dwordx4 v23, s[20:23], s74 offen offset:3072 lds
    s_add_u32 m0, s57, 118784
    s_add_u32 s74, s74, 32768
    buffer_load_dwordx4 v20, s[20:23], s74 offen lds
    buffer_load_dwordx4 v21, s[20:23], s74 offen offset:1024 lds
    buffer_load_dwordx4 v22, s[20:23], s74 offen offset:2048 lds
    buffer_load_dwordx4 v23, s[20:23], s74 offen offset:3072 lds
    s_waitcnt lgkmcnt(8)
    s_waitcnt vmcnt(8)
    v_cmp_eq_u32 vcc, v32, v30
    v_cmp_eq_u32 s[64:65], v33, v31
    s_nop 0
    s_and_b64 vcc, vcc, s[64:65]
    s_cmp_eq_u64 vcc, -1
    s_cbranch_scc0 Lslow_25
Lback_26:
    s_barrier
    s_bfe_u32 s6, s63, 524288
    s_cmp_lt_u32 s6, 28
    s_cselect_b32 s20, s32, s36
    s_cselect_b32 s21, s33, s37
    s_cselect_b32 s22, s34, s38
    s_cselect_b32 s7, 0, 28
    s_sub_u32 s6, s6, s7
    s_lshl_b32 s6, s6, 16
    s_lshl_b32 s7, s81, 7
    s_add_u32 s74, s6, s7
    s_add_u32 m0, s57, 81920
    s_nop 0
    buffer_load_dwordx4 v20, s[20:23], s74 offen lds
    buffer_load_dwordx4 v21, s[20:23], s74 offen offset:1024 lds
    buffer_load_dwordx4 v22, s[20:23], s74 offen offset:2048 lds
    buffer_load_dwordx4 v23, s[20:23], s74 offen offset:3072 lds
    s_add_u32 m0, s57, 86016
    s_add_u32 s74, s74, 32768
    buffer_load_dwordx4 v20, s[20:23], s74 offen lds
    buffer_load_dwordx4 v21, s[20:23], s74 offen offset:1024 lds
    buffer_load_dwordx4 v22, s[20:23], s74 offen offset:2048 lds
    buffer_load_dwordx4 v23, s[20:23], s74 offen offset:3072 lds
    s_waitcnt lgkmcnt(0)
    s_barrier
    s_waitcnt vmcnt(8)
    s_barrier
    s_waitcnt vmcnt(0)
    s_barrier
    s_cmp_eq_u32 s2, 0
    s_cselect_b64 vcc, -1, 0
    s_cmp_eq_u32 s46, 0
    s_cselect_b64 vcc, vcc, 0
    v_mov_b32 v40, 2147483632
    s_nop 0
    v_cndmask_b32 v40, v40, v26, vcc
    buffer_store_dwordx2 v[30:31], v40, s[12:15], 0 offen sc1
    s_endpgm
Lcompute:
    s_waitcnt lgkmcnt(0)
    s_mov_b32 s71, 0x3fb8aa3b
    s_mov_b32 s72, 0x358637bd
    s_mul_i32 s76, s82, 36
    s_lshl_b32 s77, s83, 13
    s_add_u32 s77, s77, 1048576
    s_lshr_b32 s68, s45, 2
    s_add_u32 s68, s68, s81
    s_and_b32 s68, s68, 7
    s_lshl_b32 s69, s68, 1
    s_lshr_b32 s69, 9586980, s69
    s_and_b32 s69, s69, 3
    s_add_u32 s6, s68, 0
    s_and_b32 s6, s6, 1
    s_lshl_b32 s6, s6, 3
    s_lshl_b32 s7, s46, 1
    s_add_u32 s6, s6, s7
    s_add_u32 s6, s6, 8
    s_mov_b32 s5, s6
    s_add_u32 s6, s68, 1
    s_and_b32 s6, s6, 1
    s_lshl_b32 s6, s6, 3
    s_lshl_b32 s7, s46, 1
    s_add_u32 s6, s6, s7
    s_add_u32 s6, s6, 8
    s_lshl_b32 s6, s6, 8
    s_or_b32 s5, s5, s6
    s_add_u32 s6, s68, 0
    s_and_b32 s6, s6, 3
    s_lshl_b32 s6, s6, 2
    s_add_u32 s6, s6, s46
    s_lshl_b32 s7, s6, 1
    s_sub_u32 s7, s7, 7
    s_cmp_lt_u32 s6, 8
    s_cselect_b32 s6, s6, s7
    s_lshl_b32 s6, s6, 16
    s_or_b32 s5, s5, s6
    s_add_u32 s6, s68, 1
    s_and_b32 s6, s6, 3
    s_lshl_b32 s6, s6, 2
    s_add_u32 s6, s6, s46
    s_lshl_b32 s7, s6, 1
    s_sub_u32 s7, s7, 7
    s_cmp_lt_u32 s6, 8
    s_cselect_b32 s6, s6, s7
    s_lshl_b32 s6, s6, 24
    s_or_b32 s5, s5, s6
    s_add_u32 s6, s68, 2
    s_and_b32 s6, s6, 3
    s_lshl_b32 s6, s6, 2
    s_add_u32 s6, s6, s46
    s_lshl_b32 s7, s6, 1
    s_sub_u32 s7, s7, 7
    s_cmp_lt_u32 s6, 8
    s_cselect_b32 s6, s6, s7
    s_mov_b32 s3, s6
    s_add_u32 s6, s68, 3
    s_and_b32 s6, s6, 3
    s_lshl_b32 s6, s6, 2
    s_add_u32 s6, s6, s46
    s_lshl_b32 s7, s6, 1
    s_sub_u32 s7, s7, 7
    s_cmp_lt_u32 s6, 8
    s_cselect_b32 s6, s6, s7
    s_lshl_b32 s6, s6, 8
    s_or_b32 s3, s3, s6
    s_add_u32 s6, s69, 0
    s_sub_u32 s7, s6, 3
    s_cmp_lt_u32 s6, 3
    s_cselect_b32 s6, s6, s7
    s_lshl_b32 s6, s6, 2
    s_add_u32 s6, s6, s46
    s_add_u32 s6, s6, 24
    s_lshl_b32 s6, s6, 16
    s_or_b32 s3, s3, s6
    s_add_u32 s6, s69, 1
    s_sub_u32 s7, s6, 3
    s_cmp_lt_u32 s6, 3
    s_cselect_b32 s6, s6, s7
    s_lshl_b32 s6, s6, 2
    s_add_u32 s6, s6, s46
    s_add_u32 s6, s6, 24
    s_lshl_b32 s6, s6, 24
    s_or_b32 s3, s3, s6
    s_add_u32 s6, s69, 2
    s_sub_u32 s7, s6, 3
    s_cmp_lt_u32 s6, 3
    s_cselect_b32 s6, s6, s7
    s_lshl_b32 s6, s6, 2
    s_add_u32 s6, s6, s46
    s_add_u32 s6, s6, 24
    s_mov_b32 s63, s6
    v_and_b32 v56, 31, v1
    v_lshrrev_b32 v57, 5, v1
    v_bfe_u32 v58, v1, 2, 2
    v_and_b32 v59, 3, v1
    v_bfe_u32 v60, v1, 4, 1
    v_lshlrev_b32 v61, 5, v60
    v_lshl_add_u32 v61, v59, 3, v61
    v_lshrrev_b32 v62, 1, v58
    v_lshlrev_b32 v62, 6, v62
    v_lshl_add_u32 v63, v57, 3, v58
    v_lshlrev_b32 v64, 7, v63
    v_xor_b32 v65, v61, v62
    v_add_u32 v3, v64, v65
    v_or_b32 v65, 64, v61
    v_xor_b32 v65, v65, v62
    v_add_u32 v4, v64, v65
    v_add_u32 v5, 0x10000, v3
    v_add_u32 v6, 0x10000, v4
    v_lshlrev_b32 v64, 6, v63
    v_add_u32 v7, v64, v61
    v_add_u32 v8, 0x10000, v7
    v_bfe_u32 v64, v56, 1, 3
    v_xor_b32 v64, v64, v57
    v_lshlrev_b32 v65, 7, v56
    s_add_u32 s7, s51, 81920
    v_add_u32 v65, s7, v65
    v_xor_b32 v66, 0, v64
    v_lshl_add_u32 v9, v66, 4, v65
    v_xor_b32 v66, 2, v64
    v_lshl_add_u32 v10, v66, 4, v65
    v_xor_b32 v66, 4, v64
    v_lshl_add_u32 v11, v66, 4, v65
    v_xor_b32 v66, 6, v64
    v_lshl_add_u32 v12, v66, 4, v65
    v_lshlrev_b32 v15, 4, v57
    v_lshlrev_b32 v48, 2, v56
    v_add_u32 v48, 149504, v48
    v_mov_b32 v54, 0
    v_mov_b32 v55, 0
    v_lshrrev_b32 v64, 3, v0
    v_and_b32 v65, 7, v0
    v_lshlrev_b32 v49, 10, v64
    v_lshl_add_u32 v49, v65, 4, v49
    s_lshl_b32 s6, s47, 7
    s_lshl_b32 s7, s48, 3
    s_add_u32 s6, s6, s7
    s_lshl_b32 s7, s46, 1
    s_add_u32 s75, s6, s7
    s_lshl_b32 s6, s75, 10
    buffer_load_dwordx4 v[16:19], v2, s[8:11], s6 offen
    buffer_load_dwordx4 v[20:23], v2, s[8:11], s6 offen offset:1024
    s_load_dwordx2 s[60:61], s[12:13], 0
    s_waitcnt vmcnt(0) lgkmcnt(0)
    s_add_u32 s60, s60, 1
    s_addc_u32 s61, s61, 0
    v_lshlrev_b32 v64, 16, v16
    v_and_b32 v65, 0xffff0000, v16
    v_lshlrev_b32 v66, 16, v17
    v_and_b32 v67, 0xffff0000, v17
    v_lshlrev_b32 v68, 16, v18
    v_and_b32 v69, 0xffff0000, v18
    v_lshlrev_b32 v70, 16, v19
    v_and_b32 v71, 0xffff0000, v19
    v_lshlrev_b32 v72, 16, v20
    v_and_b32 v73, 0xffff0000, v20
    v_lshlrev_b32 v74, 16, v21
    v_and_b32 v75, 0xffff0000, v21
    v_lshlrev_b32 v76, 16, v22
    v_and_b32 v77, 0xffff0000, v22
    v_lshlrev_b32 v78, 16, v23
    v_and_b32 v79, 0xffff0000, v23
    v_add_f32 v80, v64, v65
    v_add_f32 v81, v72, v73
    v_add_f32 v80, v80, v66
    v_add_f32 v81, v81, v74
    v_add_f32 v80, v80, v67
    v_add_f32 v81, v81, v75
    v_add_f32 v80, v80, v68
    v_add_f32 v81, v81, v76
    v_add_f32 v80, v80, v69
    v_add_f32 v81, v81, v77
    v_add_f32 v80, v80, v70
    v_add_f32 v81, v81, v78
    v_add_f32 v80, v80, v71
    v_add_f32 v81, v81, v79
    s_nop 0
    v_add_f32_dpp v80, v80, v80 quad_perm:[1,0,3,2] row_mask:0xf bank_mask:0xf
    v_add_f32_dpp v81, v81, v81 quad_perm:[1,0,3,2] row_mask:0xf bank_mask:0xf
    s_nop 0
    v_add_f32_dpp v80, v80, v80 quad_perm:[2,3,0,1] row_mask:0xf bank_mask:0xf
    v_add_f32_dpp v81, v81, v81 quad_perm:[2,3,0,1] row_mask:0xf bank_mask:0xf
    s_nop 0
    v_add_f32_dpp v80, v80, v80 row_half_mirror row_mask:0xf bank_mask:0xf
    v_add_f32_dpp v81, v81, v81 row_half_mirror row_mask:0xf bank_mask:0xf
    s_nop 0
    v_add_f32_dpp v80, v80, v80 row_mirror row_mask:0xf bank_mask:0xf
    v_add_f32_dpp v81, v81, v81 row_mirror row_mask:0xf bank_mask:0xf
    s_nop 0
    v_add_f32_dpp v80, v80, v80 row_bcast:15 row_mask:0xa bank_mask:0xf
    v_add_f32_dpp v81, v81, v81 row_bcast:15 row_mask:0xa bank_mask:0xf
    s_nop 0
    v_add_f32_dpp v80, v80, v80 row_bcast:31 row_mask:0xc bank_mask:0xf
    v_add_f32_dpp v81, v81, v81 row_bcast:31 row_mask:0xc bank_mask:0xf
    v_readlane_b32 s78, v80, 63
    v_readlane_b32 s79, v81, 63
    s_mov_b32 s66, 0x3b000000
    v_mov_b32 v82, s78
    v_mov_b32 v83, s79
    v_mul_f32 v82, s66, v82
    v_mul_f32 v83, s66, v83
    v_sub_f32 v64, v64, v82
    v_sub_f32 v72, v72, v83
    v_sub_f32 v65, v65, v82
    v_sub_f32 v73, v73, v83
    v_sub_f32 v66, v66, v82
    v_sub_f32 v74, v74, v83
    v_sub_f32 v67, v67, v82
    v_sub_f32 v75, v75, v83
    v_sub_f32 v68, v68, v82
    v_sub_f32 v76, v76, v83
    v_sub_f32 v69, v69, v82
    v_sub_f32 v77, v77, v83
    v_sub_f32 v70, v70, v82
    v_sub_f32 v78, v78, v83
    v_sub_f32 v71, v71, v82
    v_sub_f32 v79, v79, v83
    v_mul_f32 v80, v64, v64
    v_mul_f32 v81, v72, v72
    v_fmac_f32 v80, v65, v65
    v_fmac_f32 v81, v73, v73
    v_fmac_f32 v80, v66, v66
    v_fmac_f32 v81, v74, v74
    v_fmac_f32 v80, v67, v67
    v_fmac_f32 v81, v75, v75
    v_fmac_f32 v80, v68, v68
    v_fmac_f32 v81, v76, v76
    v_fmac_f32 v80, v69, v69
    v_fmac_f32 v81, v77, v77
    v_fmac_f32 v80, v70, v70
    v_fmac_f32 v81, v78, v78
    v_fmac_f32 v80, v71, v71
    v_fmac_f32 v81, v79, v79
    s_nop 0
    v_add_f32_dpp v80, v80, v80 quad_perm:[1,0,3,2] row_mask:0xf bank_mask:0xf
    v_add_f32_dpp v81, v81, v81 quad_perm:[1,0,3,2] row_mask:0xf bank_mask:0xf
    s_nop 0
    v_add_f32_dpp v80, v80, v80 quad_perm:[2,3,0,1] row_mask:0xf bank_mask:0xf
    v_add_f32_dpp v81, v81, v81 quad_perm:[2,3,0,1] row_mask:0xf bank_mask:0xf
    s_nop 0
    v_add_f32_dpp v80, v80, v80 row_half_mirror row_mask:0xf bank_mask:0xf
    v_add_f32_dpp v81, v81, v81 row_half_mirror row_mask:0xf bank_mask:0xf
    s_nop 0
    v_add_f32_dpp v80, v80, v80 row_mirror row_mask:0xf bank_mask:0xf
    v_add_f32_dpp v81, v81, v81 row_mirror row_mask:0xf bank_mask:0xf
    s_nop 0
    v_add_f32_dpp v80, v80, v80 row_bcast:15 row_mask:0xa bank_mask:0xf
    v_add_f32_dpp v81, v81, v81 row_bcast:15 row_mask:0xa bank_mask:0xf
    s_nop 0
    v_add_f32_dpp v80, v80, v80 row_bcast:31 row_mask:0xc bank_mask:0xf
    v_add_f32_dpp v81, v81, v81 row_bcast:31 row_mask:0xc bank_mask:0xf
    v_readlane_b32 s78, v80, 63
    v_readlane_b32 s79, v81, 63
    s_nop 0
    v_mov_b32 v84, s78
    v_mov_b32 v85, s79
    v_mov_b32 v86, 0x3727c5ac
    v_fma_f32 v84, v84, s66, v86
    v_fma_f32 v85, v85, s66, v86
    v_rsq_f32 v84, v84
    v_rsq_f32 v85, v85
    v_cmp_eq_u32 vcc, 1, v1
    v_mov_b32 v90, s60
    v_mov_b32 v91, s61
    v_cndmask_b32 v88, v82, v83, vcc
    v_cndmask_b32 v89, v84, v85, vcc
    v_cmp_gt_u32 vcc, 2, v1
    v_mov_b32 v87, 2147483632
    s_lshl_b32 s6, s75, 4
    s_add_u32 s6, s6, 65536
    v_cndmask_b32 v86, v87, v2, vcc
    buffer_store_dwordx4 v[88:91], v86, s[12:15], s6 offen sc1
    s_barrier
    ds_read_b128 a[0:3], v9 offset:0
    ds_read_b128 a[4:7], v10 offset:0
    ds_read_b128 a[8:11], v11 offset:0
    ds_read_b128 a[12:15], v12 offset:0
    ds_read_b64_tr_b16 v[16:17], v3 offset:0
    ds_read_b64_tr_b16 v[18:19], v3 offset:512
    ds_read_b64_tr_b16 v[20:21], v4 offset:0
    ds_read_b64_tr_b16 v[22:23], v4 offset:512
    ds_read_b64_tr_b16 v[24:25], v3 offset:8192
    ds_read_b64_tr_b16 v[26:27], v3 offset:8704
    ds_read_b64_tr_b16 v[28:29], v4 offset:8192
    ds_read_b64_tr_b16 v[30:31], v4 offset:8704
    ds_read_b64_tr_b16 v[32:33], v3 offset:2048
    ds_read_b64_tr_b16 v[34:35], v3 offset:2560
    ds_read_b64_tr_b16 v[36:37], v4 offset:2048
    ds_read_b64_tr_b16 v[38:39], v4 offset:2560
    s_waitcnt lgkmcnt(8)
    v_mfma_f32_32x32x16_bf16 v[64:79], v[16:19], a[0:3], 0
    ds_read_b64_tr_b16 v[40:41], v3 offset:10240
    ds_read_b64_tr_b16 v[42:43], v3 offset:10752
    v_mfma_f32_32x32x16_bf16 v[80:95], v[20:23], a[0:3], 0
    ds_read_b64_tr_b16 v[44:45], v4 offset:10240
    ds_read_b64_tr_b16 v[46:47], v4 offset:10752
    s_waitcnt lgkmcnt(8)
    v_mfma_f32_32x32x16_bf16 v[96:111], v[24:27], a[0:3], 0
    ds_read_b64_tr_b16 v[16:17], v3 offset:4096
    ds_read_b64_tr_b16 v[18:19], v3 offset:4608
    v_mfma_f32_32x32x16_bf16 v[112:127], v[28:31], a[0:3], 0
    ds_read_b64_tr_b16 v[20:21], v4 offset:4096
    ds_read_b64_tr_b16 v[22:23], v4 offset:4608
    s_waitcnt lgkmcnt(8)
    v_mfma_f32_32x32x16_bf16 v[64:79], v[32:35], a[4:7], v[64:79]
    ds_read_b64_tr_b16 v[24:25], v3 offset:12288
    ds_read_b64_tr_b16 v[26:27], v3 offset:12800
    v_mfma_f32_32x32x16_bf16 v[80:95], v[36:39], a[4:7], v[80:95]
    ds_read_b64_tr_b16 v[28:29], v4 offset:12288
    ds_read_b64_tr_b16 v[30:31], v4 offset:12800
    s_waitcnt lgkmcnt(8)
    v_mfma_f32_32x32x16_bf16 v[96:111], v[40:43], a[4:7], v[96:111]
    ds_read_b64_tr_b16 v[32:33], v3 offset:6144
    ds_read_b64_tr_b16 v[34:35], v3 offset:6656
    v_mfma_f32_32x32x16_bf16 v[112:127], v[44:47], a[4:7], v[112:127]
    ds_read_b64_tr_b16 v[36:37], v4 offset:6144
    ds_read_b64_tr_b16 v[38:39], v4 offset:6656
    s_waitcnt lgkmcnt(8)
    v_mfma_f32_32x32x16_bf16 v[64:79], v[16:19], a[8:11], v[64:79]
    ds_read_b64_tr_b16 v[40:41], v3 offset:14336
    ds_read_b64_tr_b16 v[42:43], v3 offset:14848
    v_mfma_f32_32x32x16_bf16 v[80:95], v[20:23], a[8:11], v[80:95]
    s_barrier
    ds_read_b64_tr_b16 v[44:45], v4 offset:14336
    ds_read_b64_tr_b16 v[46:47], v4 offset:14848
    s_waitcnt lgkmcnt(8)
    v_mfma_f32_32x32x16_bf16 v[96:111], v[24:27], a[8:11], v[96:111]
    ds_read_b64_tr_b16 v[16:17], v3 offset:16384
    ds_read_b64_tr_b16 v[18:19], v3 offset:16896
    v_mfma_f32_32x32x16_bf16 v[112:127], v[28:31], a[8:11], v[112:127]
    ds_read_b128 a[16:19], v9 offset:16384
    ds_read_b64_tr_b16 v[20:21], v4 offset:16384
    ds_read_b64_tr_b16 v[22:23], v4 offset:16896
    s_waitcnt lgkmcnt(9)
    v_mfma_f32_32x32x16_bf16 v[64:79], v[32:35], a[12:15], v[64:79]
    ds_read_b128 a[20:23], v10 offset:16384
    ds_read_b64_tr_b16 v[24:25], v3 offset:24576
    ds_read_b64_tr_b16 v[26:27], v3 offset:25088
    v_mfma_f32_32x32x16_bf16 v[80:95], v[36:39], a[12:15], v[80:95]
    ds_read_b128 a[24:27], v11 offset:16384
    ds_read_b64_tr_b16 v[28:29], v4 offset:24576
    ds_read_b64_tr_b16 v[30:31], v4 offset:25088
    s_waitcnt lgkmcnt(11)
    v_mfma_f32_32x32x16_bf16 v[96:111], v[40:43], a[12:15], v[96:111]
    ds_read_b128 a[28:31], v12 offset:16384
    ds_read_b64_tr_b16 v[32:33], v3 offset:18432
    ds_read_b64_tr_b16 v[34:35], v3 offset:18944
    v_mfma_f32_32x32x16_bf16 v[112:127], v[44:47], a[12:15], v[112:127]
    ds_read_b64_tr_b16 v[36:37], v4 offset:18432
    ds_read_b64_tr_b16 v[38:39], v4 offset:18944
    s_waitcnt lgkmcnt(11)
    s_waitcnt lgkmcnt(4)
    v_mfma_f32_32x32x16_bf16 v[64:79], v[16:19], a[16:19], v[64:79]
    ds_read_b64_tr_b16 v[40:41], v3 offset:26624
    ds_read_b64_tr_b16 v[42:43], v3 offset:27136
    v_mfma_f32_32x32x16_bf16 v[80:95], v[20:23], a[16:19], v[80:95]
    ds_read_b64_tr_b16 v[44:45], v4 offset:26624
    ds_read_b64_tr_b16 v[46:47], v4 offset:27136
    v_mfma_f32_32x32x16_bf16 v[96:111], v[24:27], a[16:19], v[96:111]
    ds_read_b64_tr_b16 v[16:17], v3 offset:20480
    ds_read_b64_tr_b16 v[18:19], v3 offset:20992
    v_mfma_f32_32x32x16_bf16 v[112:127], v[28:31], a[16:19], v[112:127]
    ds_read_b64_tr_b16 v[20:21], v4 offset:20480
    ds_read_b64_tr_b16 v[22:23], v4 offset:20992
    s_waitcnt lgkmcnt(8)
    v_mfma_f32_32x32x16_bf16 v[64:79], v[32:35], a[20:23], v[64:79]
    ds_read_b64_tr_b16 v[24:25], v3 offset:28672
    ds_read_b64_tr_b16 v[26:27], v3 offset:29184
    v_mfma_f32_32x32x16_bf16 v[80:95], v[36:39], a[20:23], v[80:95]
    ds_read_b64_tr_b16 v[28:29], v4 offset:28672
    ds_read_b64_tr_b16 v[30:31], v4 offset:29184
    s_waitcnt lgkmcnt(8)
    v_mfma_f32_32x32x16_bf16 v[96:111], v[40:43], a[20:23], v[96:111]
    ds_read_b64_tr_b16 v[32:33], v3 offset:22528
    ds_read_b64_tr_b16 v[34:35], v3 offset:23040
    v_mfma_f32_32x32x16_bf16 v[112:127], v[44:47], a[20:23], v[112:127]
    ds_read_b64_tr_b16 v[36:37], v4 offset:22528
    ds_read_b64_tr_b16 v[38:39], v4 offset:23040
    s_waitcnt lgkmcnt(8)
    v_mfma_f32_32x32x16_bf16 v[64:79], v[16:19], a[24:27], v[64:79]
    ds_read_b64_tr_b16 v[40:41], v3 offset:30720
    ds_read_b64_tr_b16 v[42:43], v3 offset:31232
    v_mfma_f32_32x32x16_bf16 v[80:95], v[20:23], a[24:27], v[80:95]
    s_barrier
    ds_read_b64_tr_b16 v[44:45], v4 offset:30720
    ds_read_b64_tr_b16 v[46:47], v4 offset:31232
    s_waitcnt lgkmcnt(8)
    v_mfma_f32_32x32x16_bf16 v[96:111], v[24:27], a[24:27], v[96:111]
    ds_read_b64_tr_b16 v[16:17], v3 offset:32768
    ds_read_b64_tr_b16 v[18:19], v3 offset:33280
    v_mfma_f32_32x32x16_bf16 v[112:127], v[28:31], a[24:27], v[112:127]
    ds_read_b128 a[32:35], v9 offset:32768
    ds_read_b64_tr_b16 v[20:21], v4 offset:32768
    ds_read_b64_tr_b16 v[22:23], v4 offset:33280
    s_waitcnt lgkmcnt(9)
    v_mfma_f32_32x32x16_bf16 v[64:79], v[32:35], a[28:31], v[64:79]
    ds_read_b128 a[36:39], v10 offset:32768
    ds_read_b64_tr_b16 v[24:25], v3 offset:40960
    ds_read_b64_tr_b16 v[26:27], v3 offset:41472
    v_mfma_f32_32x32x16_bf16 v[80:95], v[36:39], a[28:31], v[80:95]
    ds_read_b128 a[40:43], v11 offset:32768
    ds_read_b64_tr_b16 v[28:29], v4 offset:40960
    ds_read_b64_tr_b16 v[30:31], v4 offset:41472
    s_waitcnt lgkmcnt(11)
    v_mfma_f32_32x32x16_bf16 v[96:111], v[40:43], a[28:31], v[96:111]
    ds_read_b128 a[44:47], v12 offset:32768
    ds_read_b64_tr_b16 v[32:33], v3 offset:34816
    ds_read_b64_tr_b16 v[34:35], v3 offset:35328
    v_mfma_f32_32x32x16_bf16 v[112:127], v[44:47], a[28:31], v[112:127]
    ds_read_b64_tr_b16 v[36:37], v4 offset:34816
    ds_read_b64_tr_b16 v[38:39], v4 offset:35328
    s_waitcnt lgkmcnt(11)
    s_waitcnt lgkmcnt(4)
    v_mfma_f32_32x32x16_bf16 v[64:79], v[16:19], a[32:35], v[64:79]
    ds_read_b64_tr_b16 v[40:41], v3 offset:43008
    ds_read_b64_tr_b16 v[42:43], v3 offset:43520
    v_mfma_f32_32x32x16_bf16 v[80:95], v[20:23], a[32:35], v[80:95]
    ds_read_b64_tr_b16 v[44:45], v4 offset:43008
    ds_read_b64_tr_b16 v[46:47], v4 offset:43520
    v_mfma_f32_32x32x16_bf16 v[96:111], v[24:27], a[32:35], v[96:111]
    ds_read_b64_tr_b16 v[16:17], v3 offset:36864
    ds_read_b64_tr_b16 v[18:19], v3 offset:37376
    v_mfma_f32_32x32x16_bf16 v[112:127], v[28:31], a[32:35], v[112:127]
    ds_read_b64_tr_b16 v[20:21], v4 offset:36864
    ds_read_b64_tr_b16 v[22:23], v4 offset:37376
    s_waitcnt lgkmcnt(8)
    v_mfma_f32_32x32x16_bf16 v[64:79], v[32:35], a[36:39], v[64:79]
    ds_read_b64_tr_b16 v[24:25], v3 offset:45056
    ds_read_b64_tr_b16 v[26:27], v3 offset:45568
    v_mfma_f32_32x32x16_bf16 v[80:95], v[36:39], a[36:39], v[80:95]
    ds_read_b64_tr_b16 v[28:29], v4 offset:45056
    ds_read_b64_tr_b16 v[30:31], v4 offset:45568
    s_waitcnt lgkmcnt(8)
    v_mfma_f32_32x32x16_bf16 v[96:111], v[40:43], a[36:39], v[96:111]
    ds_read_b64_tr_b16 v[32:33], v3 offset:38912
    ds_read_b64_tr_b16 v[34:35], v3 offset:39424
    v_mfma_f32_32x32x16_bf16 v[112:127], v[44:47], a[36:39], v[112:127]
    ds_read_b64_tr_b16 v[36:37], v4 offset:38912
    ds_read_b64_tr_b16 v[38:39], v4 offset:39424
    s_waitcnt lgkmcnt(8)
    v_mfma_f32_32x32x16_bf16 v[64:79], v[16:19], a[40:43], v[64:79]
    ds_read_b64_tr_b16 v[40:41], v3 offset:47104
    ds_read_b64_tr_b16 v[42:43], v3 offset:47616
    v_mfma_f32_32x32x16_bf16 v[80:95], v[20:23], a[40:43], v[80:95]
    s_barrier
    ds_read_b64_tr_b16 v[44:45], v4 offset:47104
    ds_read_b64_tr_b16 v[46:47], v4 offset:47616
    s_waitcnt lgkmcnt(8)
    v_mfma_f32_32x32x16_bf16 v[96:111], v[24:27], a[40:43], v[96:111]
    ds_read_b64_tr_b16 v[16:17], v3 offset:49152
    ds_read_b64_tr_b16 v[18:19], v3 offset:49664
    v_mfma_f32_32x32x16_bf16 v[112:127], v[28:31], a[40:43], v[112:127]
    ds_read_b128 a[48:51], v9 offset:0
    ds_read_b64_tr_b16 v[20:21], v4 offset:49152
    ds_read_b64_tr_b16 v[22:23], v4 offset:49664
    s_waitcnt lgkmcnt(9)
    v_mfma_f32_32x32x16_bf16 v[64:79], v[32:35], a[44:47], v[64:79]
    ds_read_b128 a[52:55], v10 offset:0
    ds_read_b64_tr_b16 v[24:25], v3 offset:57344
    ds_read_b64_tr_b16 v[26:27], v3 offset:57856
    v_mfma_f32_32x32x16_bf16 v[80:95], v[36:39], a[44:47], v[80:95]
    ds_read_b128 a[56:59], v11 offset:0
    ds_read_b64_tr_b16 v[28:29], v4 offset:57344
    ds_read_b64_tr_b16 v[30:31], v4 offset:57856
    s_waitcnt lgkmcnt(11)
    v_mfma_f32_32x32x16_bf16 v[96:111], v[40:43], a[44:47], v[96:111]
    ds_read_b128 a[60:63], v12 offset:0
    ds_read_b64_tr_b16 v[32:33], v3 offset:51200
    ds_read_b64_tr_b16 v[34:35], v3 offset:51712
    v_mfma_f32_32x32x16_bf16 v[112:127], v[44:47], a[44:47], v[112:127]
    ds_read_b64_tr_b16 v[36:37], v4 offset:51200
    ds_read_b64_tr_b16 v[38:39], v4 offset:51712
    s_waitcnt lgkmcnt(11)
    s_waitcnt lgkmcnt(4)
    v_mfma_f32_32x32x16_bf16 v[64:79], v[16:19], a[48:51], v[64:79]
    ds_read_b64_tr_b16 v[40:41], v3 offset:59392
    ds_read_b64_tr_b16 v[42:43], v3 offset:59904
    v_mfma_f32_32x32x16_bf16 v[80:95], v[20:23], a[48:51], v[80:95]
    ds_read_b64_tr_b16 v[44:45], v4 offset:59392
    ds_read_b64_tr_b16 v[46:47], v4 offset:59904
    v_mfma_f32_32x32x16_bf16 v[96:111], v[24:27], a[48:51], v[96:111]
    ds_read_b64_tr_b16 v[16:17], v3 offset:53248
    ds_read_b64_tr_b16 v[18:19], v3 offset:53760
    v_mfma_f32_32x32x16_bf16 v[112:127], v[28:31], a[48:51], v[112:127]
    ds_read_b64_tr_b16 v[20:21], v4 offset:53248
    ds_read_b64_tr_b16 v[22:23], v4 offset:53760
    s_waitcnt lgkmcnt(8)
    v_mfma_f32_32x32x16_bf16 v[64:79], v[32:35], a[52:55], v[64:79]
    ds_read_b64_tr_b16 v[24:25], v3 offset:61440
    ds_read_b64_tr_b16 v[26:27], v3 offset:61952
    v_mfma_f32_32x32x16_bf16 v[80:95], v[36:39], a[52:55], v[80:95]
    ds_read_b64_tr_b16 v[28:29], v4 offset:61440
    ds_read_b64_tr_b16 v[30:31], v4 offset:61952
    s_waitcnt lgkmcnt(8)
    v_mfma_f32_32x32x16_bf16 v[96:111], v[40:43], a[52:55], v[96:111]
    ds_read_b64_tr_b16 v[32:33], v3 offset:55296
    ds_read_b64_tr_b16 v[34:35], v3 offset:55808
    v_mfma_f32_32x32x16_bf16 v[112:127], v[44:47], a[52:55], v[112:127]
    ds_read_b64_tr_b16 v[36:37], v4 offset:55296
    ds_read_b64_tr_b16 v[38:39], v4 offset:55808
    s_waitcnt lgkmcnt(8)
    v_mfma_f32_32x32x16_bf16 v[64:79], v[16:19], a[56:59], v[64:79]
    ds_read_b64_tr_b16 v[40:41], v3 offset:63488
    ds_read_b64_tr_b16 v[42:43], v3 offset:64000
    v_mfma_f32_32x32x16_bf16 v[80:95], v[20:23], a[56:59], v[80:95]
    s_barrier
    ds_read_b64_tr_b16 v[44:45], v4 offset:63488
    ds_read_b64_tr_b16 v[46:47], v4 offset:64000
    s_waitcnt lgkmcnt(8)
    v_mfma_f32_32x32x16_bf16 v[96:111], v[24:27], a[56:59], v[96:111]
    ds_read_b64_tr_b16 v[16:17], v5 offset:0
    ds_read_b64_tr_b16 v[18:19], v5 offset:512
    v_mfma_f32_32x32x16_bf16 v[112:127], v[28:31], a[56:59], v[112:127]
    ds_read_b128 a[64:67], v9 offset:16384
    ds_read_b64_tr_b16 v[20:21], v6 offset:0
    ds_read_b64_tr_b16 v[22:23], v6 offset:512
    s_waitcnt lgkmcnt(9)
    v_mfma_f32_32x32x16_bf16 v[64:79], v[32:35], a[60:63], v[64:79]
    ds_read_b128 a[68:71], v10 offset:16384
    ds_read_b64_tr_b16 v[24:25], v5 offset:8192
    ds_read_b64_tr_b16 v[26:27], v5 offset:8704
    v_mfma_f32_32x32x16_bf16 v[80:95], v[36:39], a[60:63], v[80:95]
    ds_read_b128 a[72:75], v11 offset:16384
    ds_read_b64_tr_b16 v[28:29], v6 offset:8192
    ds_read_b64_tr_b16 v[30:31], v6 offset:8704
    s_waitcnt lgkmcnt(11)
    v_mfma_f32_32x32x16_bf16 v[96:111], v[40:43], a[60:63], v[96:111]
    ds_read_b128 a[76:79], v12 offset:16384
    ds_read_b64_tr_b16 v[32:33], v5 offset:2048
    ds_read_b64_tr_b16 v[34:35], v5 offset:2560
    v_mfma_f32_32x32x16_bf16 v[112:127], v[44:47], a[60:63], v[112:127]
    ds_read_b64_tr_b16 v[36:37], v6 offset:2048
    ds_read_b64_tr_b16 v[38:39], v6 offset:2560
    s_waitcnt lgkmcnt(11)
    s_waitcnt lgkmcnt(4)
    v_mfma_f32_32x32x16_bf16 v[64:79], v[16:19], a[64:67], v[64:79]
    ds_read_b64_tr_b16 v[40:41], v5 offset:10240
    ds_read_b64_tr_b16 v[42:43], v5 offset:10752
    v_mfma_f32_32x32x16_bf16 v[80:95], v[20:23], a[64:67], v[80:95]
    ds_read_b64_tr_b16 v[44:45], v6 offset:10240
    ds_read_b64_tr_b16 v[46:47], v6 offset:10752
    v_mfma_f32_32x32x16_bf16 v[96:111], v[24:27], a[64:67], v[96:111]
    ds_read_b64_tr_b16 v[16:17], v5 offset:4096
    ds_read_b64_tr_b16 v[18:19], v5 offset:4608
    v_mfma_f32_32x32x16_bf16 v[112:127], v[28:31], a[64:67], v[112:127]
    ds_read_b64_tr_b16 v[20:21], v6 offset:4096
    ds_read_b64_tr_b16 v[22:23], v6 offset:4608
    s_waitcnt lgkmcnt(8)
    v_mfma_f32_32x32x16_bf16 v[64:79], v[32:35], a[68:71], v[64:79]
    ds_read_b64_tr_b16 v[24:25], v5 offset:12288
    ds_read_b64_tr_b16 v[26:27], v5 offset:12800
    v_mfma_f32_32x32x16_bf16 v[80:95], v[36:39], a[68:71], v[80:95]
    ds_read_b64_tr_b16 v[28:29], v6 offset:12288
    ds_read_b64_tr_b16 v[30:31], v6 offset:12800
    s_waitcnt lgkmcnt(8)
    v_mfma_f32_32x32x16_bf16 v[96:111], v[40:43], a[68:71], v[96:111]
    ds_read_b64_tr_b16 v[32:33], v5 offset:6144
    ds_read_b64_tr_b16 v[34:35], v5 offset:6656
    v_mfma_f32_32x32x16_bf16 v[112:127], v[44:47], a[68:71], v[112:127]
    ds_read_b64_tr_b16 v[36:37], v6 offset:6144
    ds_read_b64_tr_b16 v[38:39], v6 offset:6656
    s_waitcnt lgkmcnt(8)
    v_mfma_f32_32x32x16_bf16 v[64:79], v[16:19], a[72:75], v[64:79]
    ds_read_b64_tr_b16 v[40:41], v5 offset:14336
    ds_read_b64_tr_b16 v[42:43], v5 offset:14848
    v_mfma_f32_32x32x16_bf16 v[80:95], v[20:23], a[72:75], v[80:95]
    s_barrier
    ds_read_b64_tr_b16 v[44:45], v6 offset:14336
    ds_read_b64_tr_b16 v[46:47], v6 offset:14848
    s_waitcnt lgkmcnt(8)
    v_mfma_f32_32x32x16_bf16 v[96:111], v[24:27], a[72:75], v[96:111]
    ds_read_b64_tr_b16 v[16:17], v3 offset:0
    ds_read_b64_tr_b16 v[18:19], v3 offset:512
    v_mfma_f32_32x32x16_bf16 v[112:127], v[28:31], a[72:75], v[112:127]
    ds_read_b128 a[80:83], v9 offset:32768
    ds_read_b64_tr_b16 v[20:21], v4 offset:0
    ds_read_b64_tr_b16 v[22:23], v4 offset:512
    s_waitcnt lgkmcnt(9)
    v_mfma_f32_32x32x16_bf16 v[64:79], v[32:35], a[76:79], v[64:79]
    ds_read_b128 a[84:87], v10 offset:32768
    ds_read_b64_tr_b16 v[24:25], v3 offset:8192
    ds_read_b64_tr_b16 v[26:27], v3 offset:8704
    v_mfma_f32_32x32x16_bf16 v[80:95], v[36:39], a[76:79], v[80:95]
    ds_read_b128 a[88:91], v11 offset:32768
    ds_read_b64_tr_b16 v[28:29], v4 offset:8192
    ds_read_b64_tr_b16 v[30:31], v4 offset:8704
    s_waitcnt lgkmcnt(11)
    v_mfma_f32_32x32x16_bf16 v[96:111], v[40:43], a[76:79], v[96:111]
    ds_read_b128 a[92:95], v12 offset:32768
    ds_read_b64_tr_b16 v[32:33], v3 offset:2048
    ds_read_b64_tr_b16 v[34:35], v3 offset:2560
    v_mfma_f32_32x32x16_bf16 v[112:127], v[44:47], a[76:79], v[112:127]
    ds_read_b64_tr_b16 v[36:37], v4 offset:2048
    ds_read_b64_tr_b16 v[38:39], v4 offset:2560
    s_waitcnt lgkmcnt(11)
    s_waitcnt lgkmcnt(4)
    v_mfma_f32_32x32x16_bf16 v[64:79], v[16:19], a[80:83], v[64:79]
    ds_read_b64_tr_b16 v[40:41], v3 offset:10240
    ds_read_b64_tr_b16 v[42:43], v3 offset:10752
    v_mfma_f32_32x32x16_bf16 v[80:95], v[20:23], a[80:83], v[80:95]
    ds_read_b64_tr_b16 v[44:45], v4 offset:10240
    ds_read_b64_tr_b16 v[46:47], v4 offset:10752
    v_mfma_f32_32x32x16_bf16 v[96:111], v[24:27], a[80:83], v[96:111]
    ds_read_b64_tr_b16 v[16:17], v3 offset:4096
    ds_read_b64_tr_b16 v[18:19], v3 offset:4608
    v_mfma_f32_32x32x16_bf16 v[112:127], v[28:31], a[80:83], v[112:127]
    ds_read_b64_tr_b16 v[20:21], v4 offset:4096
    ds_read_b64_tr_b16 v[22:23], v4 offset:4608
    s_waitcnt lgkmcnt(8)
    v_mfma_f32_32x32x16_bf16 v[64:79], v[32:35], a[84:87], v[64:79]
    ds_read_b64_tr_b16 v[24:25], v3 offset:12288
    ds_read_b64_tr_b16 v[26:27], v3 offset:12800
    v_mfma_f32_32x32x16_bf16 v[80:95], v[36:39], a[84:87], v[80:95]
    ds_read_b64_tr_b16 v[28:29], v4 offset:12288
    ds_read_b64_tr_b16 v[30:31], v4 offset:12800
    s_waitcnt lgkmcnt(8)
    v_mfma_f32_32x32x16_bf16 v[96:111], v[40:43], a[84:87], v[96:111]
    ds_read_b64_tr_b16 v[32:33], v3 offset:6144
    ds_read_b64_tr_b16 v[34:35], v3 offset:6656
    v_mfma_f32_32x32x16_bf16 v[112:127], v[44:47], a[84:87], v[112:127]
    ds_read_b64_tr_b16 v[36:37], v4 offset:6144
    ds_read_b64_tr_b16 v[38:39], v4 offset:6656
    s_waitcnt lgkmcnt(8)
    v_mfma_f32_32x32x16_bf16 v[64:79], v[16:19], a[88:91], v[64:79]
    ds_read_b64_tr_b16 v[40:41], v3 offset:14336
    ds_read_b64_tr_b16 v[42:43], v3 offset:14848
    v_mfma_f32_32x32x16_bf16 v[80:95], v[20:23], a[88:91], v[80:95]
    s_barrier
    ds_read_b64_tr_b16 v[44:45], v4 offset:14336
    ds_read_b64_tr_b16 v[46:47], v4 offset:14848
    s_waitcnt lgkmcnt(8)
    v_mfma_f32_32x32x16_bf16 v[96:111], v[24:27], a[88:91], v[96:111]
    ds_read_b64_tr_b16 v[16:17], v3 offset:16384
    ds_read_b64_tr_b16 v[18:19], v3 offset:16896
    v_mfma_f32_32x32x16_bf16 v[112:127], v[28:31], a[88:91], v[112:127]
    ds_read_b128 a[96:99], v9 offset:0
    ds_read_b64_tr_b16 v[20:21], v4 offset:16384
    ds_read_b64_tr_b16 v[22:23], v4 offset:16896
    s_waitcnt lgkmcnt(9)
    v_mfma_f32_32x32x16_bf16 v[64:79], v[32:35], a[92:95], v[64:79]
    ds_read_b128 a[100:103], v10 offset:0
    ds_read_b64_tr_b16 v[24:25], v3 offset:24576
    ds_read_b64_tr_b16 v[26:27], v3 offset:25088
    v_mfma_f32_32x32x16_bf16 v[80:95], v[36:39], a[92:95], v[80:95]
    ds_read_b128 a[104:107], v11 offset:0
    ds_read_b64_tr_b16 v[28:29], v4 offset:24576
    ds_read_b64_tr_b16 v[30:31], v4 offset:25088
    s_waitcnt lgkmcnt(11)
    v_mfma_f32_32x32x16_bf16 v[96:111], v[40:43], a[92:95], v[96:111]
    ds_read_b128 a[108:111], v12 offset:0
    ds_read_b64_tr_b16 v[32:33], v3 offset:18432
    ds_read_b64_tr_b16 v[34:35], v3 offset:18944
    v_mfma_f32_32x32x16_bf16 v[112:127], v[44:47], a[92:95], v[112:127]
    ds_read_b64_tr_b16 v[36:37], v4 offset:18432
    ds_read_b64_tr_b16 v[38:39], v4 offset:18944
    s_waitcnt lgkmcnt(11)
    s_waitcnt lgkmcnt(4)
    v_mfma_f32_32x32x16_bf16 v[64:79], v[16:19], a[96:99], v[64:79]
    ds_read_b64_tr_b16 v[40:41], v3 offset:26624
    ds_read_b64_tr_b16 v[42:43], v3 offset:27136
    v_mfma_f32_32x32x16_bf16 v[80:95], v[20:23], a[96:99], v[80:95]
    ds_read_b64_tr_b16 v[44:45], v4 offset:26624
    ds_read_b64_tr_b16 v[46:47], v4 offset:27136
    v_mfma_f32_32x32x16_bf16 v[96:111], v[24:27], a[96:99], v[96:111]
    ds_read_b64_tr_b16 v[16:17], v3 offset:20480
    ds_read_b64_tr_b16 v[18:19], v3 offset:20992
    v_mfma_f32_32x32x16_bf16 v[112:127], v[28:31], a[96:99], v[112:127]
    ds_read_b64_tr_b16 v[20:21], v4 offset:20480
    ds_read_b64_tr_b16 v[22:23], v4 offset:20992
    s_waitcnt lgkmcnt(8)
    v_mfma_f32_32x32x16_bf16 v[64:79], v[32:35], a[100:103], v[64:79]
    ds_read_b64_tr_b16 v[24:25], v3 offset:28672
    ds_read_b64_tr_b16 v[26:27], v3 offset:29184
    v_mfma_f32_32x32x16_bf16 v[80:95], v[36:39], a[100:103], v[80:95]
    ds_read_b64_tr_b16 v[28:29], v4 offset:28672
    ds_read_b64_tr_b16 v[30:31], v4 offset:29184
    s_waitcnt lgkmcnt(8)
    v_mfma_f32_32x32x16_bf16 v[96:111], v[40:43], a[100:103], v[96:111]
    ds_read_b64_tr_b16 v[32:33], v3 offset:22528
    ds_read_b64_tr_b16 v[34:35], v3 offset:23040
    v_mfma_f32_32x32x16_bf16 v[112:127], v[44:47], a[100:103], v[112:127]
    ds_read_b64_tr_b16 v[36:37], v4 offset:22528
    ds_read_b64_tr_b16 v[38:39], v4 offset:23040
    s_waitcnt lgkmcnt(8)
    v_mfma_f32_32x32x16_bf16 v[64:79], v[16:19], a[104:107], v[64:79]
    ds_read_b64_tr_b16 v[40:41], v3 offset:30720
    ds_read_b64_tr_b16 v[42:43], v3 offset:31232
    v_mfma_f32_32x32x16_bf16 v[80:95], v[20:23], a[104:107], v[80:95]
    s_barrier
    ds_read_b64_tr_b16 v[44:45], v4 offset:30720
    ds_read_b64_tr_b16 v[46:47], v4 offset:31232
    s_waitcnt lgkmcnt(8)
    v_mfma_f32_32x32x16_bf16 v[96:111], v[24:27], a[104:107], v[96:111]
    ds_read_b64_tr_b16 v[16:17], v3 offset:32768
    ds_read_b64_tr_b16 v[18:19], v3 offset:33280
    v_mfma_f32_32x32x16_bf16 v[112:127], v[28:31], a[104:107], v[112:127]
    ds_read_b128 a[112:115], v9 offset:16384
    ds_read_b64_tr_b16 v[20:21], v4 offset:32768
    ds_read_b64_tr_b16 v[22:23], v4 offset:33280
    s_waitcnt lgkmcnt(9)
    v_mfma_f32_32x32x16_bf16 v[64:79], v[32:35], a[108:111], v[64:79]
    ds_read_b128 a[116:119], v10 offset:16384
    ds_read_b64_tr_b16 v[24:25], v3 offset:40960
    ds_read_b64_tr_b16 v[26:27], v3 offset:41472
    v_mfma_f32_32x32x16_bf16 v[80:95], v[36:39], a[108:111], v[80:95]
    ds_read_b128 a[120:123], v11 offset:16384
    ds_read_b64_tr_b16 v[28:29], v4 offset:40960
    ds_read_b64_tr_b16 v[30:31], v4 offset:41472
    s_waitcnt lgkmcnt(11)
    v_mfma_f32_32x32x16_bf16 v[96:111], v[40:43], a[108:111], v[96:111]
    ds_read_b128 a[124:127], v12 offset:16384
    ds_read_b64_tr_b16 v[32:33], v3 offset:34816
    ds_read_b64_tr_b16 v[34:35], v3 offset:35328
    v_mfma_f32_32x32x16_bf16 v[112:127], v[44:47], a[108:111], v[112:127]
    ds_read_b64_tr_b16 v[36:37], v4 offset:34816
    ds_read_b64_tr_b16 v[38:39], v4 offset:35328
    s_waitcnt lgkmcnt(11)
    s_waitcnt lgkmcnt(4)
    v_mfma_f32_32x32x16_bf16 v[64:79], v[16:19], a[112:115], v[64:79]
    ds_read_b64_tr_b16 v[40:41], v3 offset:43008
    ds_read_b64_tr_b16 v[42:43], v3 offset:43520
    v_mfma_f32_32x32x16_bf16 v[80:95], v[20:23], a[112:115], v[80:95]
    ds_read_b64_tr_b16 v[44:45], v4 offset:43008
    ds_read_b64_tr_b16 v[46:47], v4 offset:43520
    v_mfma_f32_32x32x16_bf16 v[96:111], v[24:27], a[112:115], v[96:111]
    ds_read_b64_tr_b16 v[16:17], v3 offset:36864
    ds_read_b64_tr_b16 v[18:19], v3 offset:37376
    v_mfma_f32_32x32x16_bf16 v[112:127], v[28:31], a[112:115], v[112:127]
    ds_read_b64_tr_b16 v[20:21], v4 offset:36864
    ds_read_b64_tr_b16 v[22:23], v4 offset:37376
    s_waitcnt lgkmcnt(8)
    v_mfma_f32_32x32x16_bf16 v[64:79], v[32:35], a[116:119], v[64:79]
    ds_read_b64_tr_b16 v[24:25], v3 offset:45056
    ds_read_b64_tr_b16 v[26:27], v3 offset:45568
    v_mfma_f32_32x32x16_bf16 v[80:95], v[36:39], a[116:119], v[80:95]
    ds_read_b64_tr_b16 v[28:29], v4 offset:45056
    ds_read_b64_tr_b16 v[30:31], v4 offset:45568
    s_waitcnt lgkmcnt(8)
    v_mfma_f32_32x32x16_bf16 v[96:111], v[40:43], a[116:119], v[96:111]
    ds_read_b64_tr_b16 v[32:33], v3 offset:38912
    ds_read_b64_tr_b16 v[34:35], v3 offset:39424
    v_mfma_f32_32x32x16_bf16 v[112:127], v[44:47], a[116:119], v[112:127]
    ds_read_b64_tr_b16 v[36:37], v4 offset:38912
    ds_read_b64_tr_b16 v[38:39], v4 offset:39424
    s_waitcnt lgkmcnt(8)
    v_mfma_f32_32x32x16_bf16 v[64:79], v[16:19], a[120:123], v[64:79]
    ds_read_b64_tr_b16 v[40:41], v3 offset:47104
    ds_read_b64_tr_b16 v[42:43], v3 offset:47616
    v_mfma_f32_32x32x16_bf16 v[80:95], v[20:23], a[120:123], v[80:95]
    s_barrier
    ds_read_b64_tr_b16 v[44:45], v4 offset:47104
    ds_read_b64_tr_b16 v[46:47], v4 offset:47616
    s_waitcnt lgkmcnt(8)
    v_mfma_f32_32x32x16_bf16 v[96:111], v[24:27], a[120:123], v[96:111]
    v_mfma_f32_32x32x16_bf16 v[112:127], v[28:31], a[120:123], v[112:127]
    s_waitcnt lgkmcnt(4)
    v_mfma_f32_32x32x16_bf16 v[64:79], v[32:35], a[124:127], v[64:79]
    v_mfma_f32_32x32x16_bf16 v[80:95], v[36:39], a[124:127], v[80:95]
    s_waitcnt lgkmcnt(0)
    v_mfma_f32_32x32x16_bf16 v[96:111], v[40:43], a[124:127], v[96:111]
    v_mfma_f32_32x32x16_bf16 v[112:127], v[44:47], a[124:127], v[112:127]
    s_lshr_b32 s6, s45, 2
    s_mul_i32 s6, s6, 288
    s_mul_i32 s7, s46, 72
    s_add_u32 s6, s6, s7
    v_add_u32 v56, s6, v1
    v_lshlrev_b32 v56, 10, v56
    s_lshl_b32 s65, s81, 7
    v_mov_b32 v58, 2147483632
    v_add_u32 v57, 0, v56
    buffer_load_dword v50, v57, s[32:35], s65 offen
    v_subrev_u32 v60, 1835008, v57
    buffer_load_dword v50, v60, s[36:39], s65 offen
    v_add_u32 v57, 65536, v56
    v_cmp_gt_u32 vcc, 8, v1
    s_nop 1
    v_cndmask_b32 v57, v58, v57, vcc
    buffer_load_dword v50, v57, s[32:35], s65 offen
    v_subrev_u32 v60, 1835008, v57
    buffer_load_dword v50, v60, s[36:39], s65 offen
    v_and_b32 v44, 31, v1
    v_lshlrev_b32 v44, 3, v44
    s_lshl_b32 s6, s46, 8
    s_add_u32 s6, s6, 151040
    v_add_u32 v44, s6, v44
    ds_read_b64 v[46:47], v44
    s_waitcnt lgkmcnt(0)
    v_mov_b32 v13, v47
    v_mul_f32 v14, s71, v47
    v_cvt_pk_bf16_f32 v52, v46, v46
    v_lshlrev_b32 v45, 16, v52
    v_sub_f32 v45, v46, v45
    v_cvt_pk_bf16_f32 v53, v45, v45
    v_cmp_gt_u32 vcc, 32, v1
    v_mov_b32 v45, 0
    s_nop 0
    v_cndmask_b32 v52, v45, v52, vcc
    v_cndmask_b32 v53, v45, v53, vcc
    s_cmp_eq_u32 s50, 0
    s_cbranch_scc0 Lo_27
    ds_read_b32 v16, v48 offset:0
    ds_read_b32 v17, v48 offset:0
    v_mov_b32 v18, 0
    v_mov_b32 v19, 0
    ds_read_b32 v20, v48 offset:128
    ds_read_b32 v21, v48 offset:128
    v_mov_b32 v22, 0
    v_mov_b32 v23, 0
    ds_read_b32 v24, v48 offset:256
    ds_read_b32 v25, v48 offset:256
    v_mov_b32 v26, 0
    v_mov_b32 v27, 0
    ds_read_b32 v28, v48 offset:384
    ds_read_b32 v29, v48 offset:384
    v_mov_b32 v30, 0
    v_mov_b32 v31, 0
    s_waitcnt lgkmcnt(6)
    v_mfma_f32_32x32x16_bf16 v[64:79], v[16:19], v[52:55], v[64:79]
    s_waitcnt lgkmcnt(4)
    v_mfma_f32_32x32x16_bf16 v[80:95], v[20:23], v[52:55], v[80:95]
    s_waitcnt lgkmcnt(2)
    v_mfma_f32_32x32x16_bf16 v[96:111], v[24:27], v[52:55], v[96:111]
    s_waitcnt lgkmcnt(0)
    v_mfma_f32_32x32x16_bf16 v[112:127], v[28:31], v[52:55], v[112:127]
    v_and_b32 v32, 31, v1
    s_lshl_b32 s6, s46, 5
    v_add_u32 v32, s6, v32
    s_movk_i32 s7, 136
    v_mul_lo_u32 v32, v32, s7
    v_lshrrev_b32 v33, 1, v15
    v_add_u32 v32, v32, v33
    v_add_u32 v32, 81920, v32
    v_mov_b32 v34, v13
    v_mov_b32 v35, v13
    v_mul_f32 v56, v14, v64
    v_mul_f32 v57, v14, v65
    v_mul_f32 v58, v14, v66
    v_mul_f32 v59, v14, v67
    v_mul_f32 v60, v14, v68
    v_mul_f32 v61, v14, v69
    v_mul_f32 v62, v14, v70
    v_mul_f32 v63, v14, v71
    v_exp_f32 v56, v56 clamp
    v_exp_f32 v57, v57 clamp
    v_exp_f32 v58, v58 clamp
    v_exp_f32 v59, v59 clamp
    v_exp_f32 v60, v60 clamp
    v_exp_f32 v61, v61 clamp
    v_exp_f32 v62, v62 clamp
    v_exp_f32 v63, v63 clamp
    v_fma_f32 v64, v64, v13, s72
    v_fma_f32 v65, v65, v13, s72
    v_fma_f32 v66, v66, v13, s72
    v_fma_f32 v67, v67, v13, s72
    v_fma_f32 v68, v68, v13, s72
    v_fma_f32 v69, v69, v13, s72
    v_fma_f32 v70, v70, v13, s72
    v_fma_f32 v71, v71, v13, s72
    v_max_f32 v64, s72, v64
    v_max_f32 v65, s72, v65
    v_max_f32 v66, s72, v66
    v_max_f32 v67, s72, v67
    v_max_f32 v68, s72, v68
    v_max_f32 v69, s72, v69
    v_max_f32 v70, s72, v70
    v_max_f32 v71, s72, v71
    v_pk_add_f32 v[64:65], v[64:65], v[56:57]
    v_pk_add_f32 v[66:67], v[66:67], v[58:59]
    v_pk_add_f32 v[68:69], v[68:69], v[60:61]
    v_pk_add_f32 v[70:71], v[70:71], v[62:63]
    v_mul_f32 v56, v14, v72
    v_mul_f32 v57, v14, v73
    v_mul_f32 v58, v14, v74
    v_mul_f32 v59, v14, v75
    v_mul_f32 v60, v14, v76
    v_mul_f32 v61, v14, v77
    v_mul_f32 v62, v14, v78
    v_mul_f32 v63, v14, v79
    v_exp_f32 v56, v56 clamp
    v_exp_f32 v57, v57 clamp
    v_exp_f32 v58, v58 clamp
    v_exp_f32 v59, v59 clamp
    v_exp_f32 v60, v60 clamp
    v_exp_f32 v61, v61 clamp
    v_exp_f32 v62, v62 clamp
    v_exp_f32 v63, v63 clamp
    v_fma_f32 v72, v72, v13, s72
    v_fma_f32 v73, v73, v13, s72
    v_fma_f32 v74, v74, v13, s72
    v_fma_f32 v75, v75, v13, s72
    v_fma_f32 v76, v76, v13, s72
    v_fma_f32 v77, v77, v13, s72
    v_fma_f32 v78, v78, v13, s72
    v_fma_f32 v79, v79, v13, s72
    v_max_f32 v72, s72, v72
    v_max_f32 v73, s72, v73
    v_max_f32 v74, s72, v74
    v_max_f32 v75, s72, v75
    v_max_f32 v76, s72, v76
    v_max_f32 v77, s72, v77
    v_max_f32 v78, s72, v78
    v_max_f32 v79, s72, v79
    v_pk_add_f32 v[72:73], v[72:73], v[56:57]
    v_pk_add_f32 v[74:75], v[74:75], v[58:59]
    v_pk_add_f32 v[76:77], v[76:77], v[60:61]
    v_pk_add_f32 v[78:79], v[78:79], v[62:63]
    v_cvt_pk_bf16_f32 v36, v64, v65
    v_cvt_pk_bf16_f32 v37, v66, v67
    v_cvt_pk_bf16_f32 v38, v68, v69
    v_cvt_pk_bf16_f32 v39, v70, v71
    v_cvt_pk_bf16_f32 v40, v72, v73
    v_cvt_pk_bf16_f32 v41, v74, v75
    v_cvt_pk_bf16_f32 v42, v76, v77
    v_cvt_pk_bf16_f32 v43, v78, v79
    ds_write_b64 v32, v[36:37] offset:0
    ds_write_b64 v32, v[38:39] offset:16
    ds_write_b64 v32, v[40:41] offset:32
    ds_write_b64 v32, v[42:43] offset:48
    v_mul_f32 v56, v14, v80
    v_mul_f32 v57, v14, v81
    v_mul_f32 v58, v14, v82
    v_mul_f32 v59, v14, v83
    v_mul_f32 v60, v14, v84
    v_mul_f32 v61, v14, v85
    v_mul_f32 v62, v14, v86
    v_mul_f32 v63, v14, v87
    v_exp_f32 v56, v56 clamp
    v_exp_f32 v57, v57 clamp
    v_exp_f32 v58, v58 clamp
    v_exp_f32 v59, v59 clamp
    v_exp_f32 v60, v60 clamp
    v_exp_f32 v61, v61 clamp
    v_exp_f32 v62, v62 clamp
    v_exp_f32 v63, v63 clamp
    v_fma_f32 v80, v80, v13, s72
    v_fma_f32 v81, v81, v13, s72
    v_fma_f32 v82, v82, v13, s72
    v_fma_f32 v83, v83, v13, s72
    v_fma_f32 v84, v84, v13, s72
    v_fma_f32 v85, v85, v13, s72
    v_fma_f32 v86, v86, v13, s72
    v_fma_f32 v87, v87, v13, s72
    v_max_f32 v80, s72, v80
    v_max_f32 v81, s72, v81
    v_max_f32 v82, s72, v82
    v_max_f32 v83, s72, v83
    v_max_f32 v84, s72, v84
    v_max_f32 v85, s72, v85
    v_max_f32 v86, s72, v86
    v_max_f32 v87, s72, v87
    v_pk_add_f32 v[80:81], v[80:81], v[56:57]
    v_pk_add_f32 v[82:83], v[82:83], v[58:59]
    v_pk_add_f32 v[84:85], v[84:85], v[60:61]
    v_pk_add_f32 v[86:87], v[86:87], v[62:63]
    v_mul_f32 v56, v14, v88
    v_mul_f32 v57, v14, v89
    v_mul_f32 v58, v14, v90
    v_mul_f32 v59, v14, v91
    v_mul_f32 v60, v14, v92
    v_mul_f32 v61, v14, v93
    v_mul_f32 v62, v14, v94
    v_mul_f32 v63, v14, v95
    v_exp_f32 v56, v56 clamp
    v_exp_f32 v57, v57 clamp
    v_exp_f32 v58, v58 clamp
    v_exp_f32 v59, v59 clamp
    v_exp_f32 v60, v60 clamp
    v_exp_f32 v61, v61 clamp
    v_exp_f32 v62, v62 clamp
    v_exp_f32 v63, v63 clamp
    v_fma_f32 v88, v88, v13, s72
    v_fma_f32 v89, v89, v13, s72
    v_fma_f32 v90, v90, v13, s72
    v_fma_f32 v91, v91, v13, s72
    v_fma_f32 v92, v92, v13, s72
    v_fma_f32 v93, v93, v13, s72
    v_fma_f32 v94, v94, v13, s72
    v_fma_f32 v95, v95, v13, s72
    v_max_f32 v88, s72, v88
    v_max_f32 v89, s72, v89
    v_max_f32 v90, s72, v90
    v_max_f32 v91, s72, v91
    v_max_f32 v92, s72, v92
    v_max_f32 v93, s72, v93
    v_max_f32 v94, s72, v94
    v_max_f32 v95, s72, v95
    v_pk_add_f32 v[88:89], v[88:89], v[56:57]
    v_pk_add_f32 v[90:91], v[90:91], v[58:59]
    v_pk_add_f32 v[92:93], v[92:93], v[60:61]
    v_pk_add_f32 v[94:95], v[94:95], v[62:63]
    v_cvt_pk_bf16_f32 v36, v80, v81
    v_cvt_pk_bf16_f32 v37, v82, v83
    v_cvt_pk_bf16_f32 v38, v84, v85
    v_cvt_pk_bf16_f32 v39, v86, v87
    v_cvt_pk_bf16_f32 v40, v88, v89
    v_cvt_pk_bf16_f32 v41, v90, v91
    v_cvt_pk_bf16_f32 v42, v92, v93
    v_cvt_pk_bf16_f32 v43, v94, v95
    ds_write_b64 v32, v[36:37] offset:64
    ds_write_b64 v32, v[38:39] offset:80
    ds_write_b64 v32, v[40:41] offset:96
    ds_write_b64 v32, v[42:43] offset:112
    v_pk_mul_f32 v[96:97], v[96:97], v[34:35]
    v_pk_mul_f32 v[98:99], v[98:99], v[34:35]
    v_pk_mul_f32 v[100:101], v[100:101], v[34:35]
    v_pk_mul_f32 v[102:103], v[102:103], v[34:35]
    v_pk_mul_f32 v[104:105], v[104:105], v[34:35]
    v_pk_mul_f32 v[106:107], v[106:107], v[34:35]
    v_pk_mul_f32 v[108:109], v[108:109], v[34:35]
    v_pk_mul_f32 v[110:111], v[110:111], v[34:35]
    v_cvt_pk_bf16_f32 v36, v96, v97
    v_cvt_pk_bf16_f32 v37, v98, v99
    v_cvt_pk_bf16_f32 v38, v100, v101
    v_cvt_pk_bf16_f32 v39, v102, v103
    v_cvt_pk_bf16_f32 v40, v104, v105
    v_cvt_pk_bf16_f32 v41, v106, v107
    v_cvt_pk_bf16_f32 v42, v108, v109
    v_cvt_pk_bf16_f32 v43, v110, v111
    ds_write_b64 v32, v[36:37] offset:17408
    ds_write_b64 v32, v[38:39] offset:17424
    ds_write_b64 v32, v[40:41] offset:17440
    ds_write_b64 v32, v[42:43] offset:17456
    v_pk_mul_f32 v[112:113], v[112:113], v[34:35]
    v_pk_mul_f32 v[114:115], v[114:115], v[34:35]
    v_pk_mul_f32 v[116:117], v[116:117], v[34:35]
    v_pk_mul_f32 v[118:119], v[118:119], v[34:35]
    v_pk_mul_f32 v[120:121], v[120:121], v[34:35]
    v_pk_mul_f32 v[122:123], v[122:123], v[34:35]
    v_pk_mul_f32 v[124:125], v[124:125], v[34:35]
    v_pk_mul_f32 v[126:127], v[126:127], v[34:35]
    v_cvt_pk_bf16_f32 v36, v112, v113
    v_cvt_pk_bf16_f32 v37, v114, v115
    v_cvt_pk_bf16_f32 v38, v116, v117
    v_cvt_pk_bf16_f32 v39, v118, v119
    v_cvt_pk_bf16_f32 v40, v120, v121
    v_cvt_pk_bf16_f32 v41, v122, v123
    v_cvt_pk_bf16_f32 v42, v124, v125
    v_cvt_pk_bf16_f32 v43, v126, v127
    ds_write_b64 v32, v[36:37] offset:17472
    ds_write_b64 v32, v[38:39] offset:17488
    ds_write_b64 v32, v[40:41] offset:17504
    ds_write_b64 v32, v[42:43] offset:17520
    s_branch Lj_28
Lo_27:
    ds_read_b32 v16, v48 offset:0
    ds_read_b32 v17, v48 offset:0
    v_mov_b32 v18, 0
    v_mov_b32 v19, 0
    ds_read_b32 v20, v48 offset:128
    ds_read_b32 v21, v48 offset:128
    v_mov_b32 v22, 0
    v_mov_b32 v23, 0
    ds_read_b32 v24, v48 offset:256
    ds_read_b32 v25, v48 offset:256
    v_mov_b32 v26, 0
    v_mov_b32 v27, 0
    ds_read_b32 v28, v48 offset:384
    ds_read_b32 v29, v48 offset:384
    v_mov_b32 v30, 0
    v_mov_b32 v31, 0
    s_waitcnt lgkmcnt(6)
    v_mfma_f32_32x32x16_bf16 v[64:79], v[16:19], v[52:55], v[64:79]
    s_waitcnt lgkmcnt(4)
    v_mfma_f32_32x32x16_bf16 v[80:95], v[20:23], v[52:55], v[80:95]
    s_waitcnt lgkmcnt(2)
    v_mfma_f32_32x32x16_bf16 v[96:111], v[24:27], v[52:55], v[96:111]
    s_waitcnt lgkmcnt(0)
    v_mfma_f32_32x32x16_bf16 v[112:127], v[28:31], v[52:55], v[112:127]
    s_lshl_b32 s6, s49, 1
    s_add_u32 s6, s6, 8
    s_mul_i32 s7, s47, 36
    s_add_u32 s7, s7, s6
    s_lshl_b32 s7, s7, 2
    s_add_u32 s7, s7, s46
    s_lshl_b32 s7, s7, 12
    s_add_u32 s70, s7, 1048576
    v_max_f32 v64, 0, v64
    v_max_f32 v65, 0, v65
    v_max_f32 v66, 0, v66
    v_max_f32 v67, 0, v67
    v_max_f32 v68, 0, v68
    v_max_f32 v69, 0, v69
    v_max_f32 v70, 0, v70
    v_max_f32 v71, 0, v71
    v_max_f32 v72, 0, v72
    v_max_f32 v73, 0, v73
    v_max_f32 v74, 0, v74
    v_max_f32 v75, 0, v75
    v_max_f32 v76, 0, v76
    v_max_f32 v77, 0, v77
    v_max_f32 v78, 0, v78
    v_max_f32 v79, 0, v79
    v_pk_mul_f32 v[64:65], v[64:65], v[96:97]
    v_pk_mul_f32 v[66:67], v[66:67], v[98:99]
    v_pk_mul_f32 v[68:69], v[68:69], v[100:101]
    v_pk_mul_f32 v[70:71], v[70:71], v[102:103]
    v_pk_mul_f32 v[72:73], v[72:73], v[104:105]
    v_pk_mul_f32 v[74:75], v[74:75], v[106:107]
    v_pk_mul_f32 v[76:77], v[76:77], v[108:109]
    v_pk_mul_f32 v[78:79], v[78:79], v[110:111]
    v_cvt_pk_bf16_f32 v32, v64, v65
    v_cvt_pk_bf16_f32 v33, v66, v67
    v_cvt_pk_bf16_f32 v34, v68, v69
    v_cvt_pk_bf16_f32 v35, v70, v71
    v_cvt_pk_bf16_f32 v36, v72, v73
    v_cvt_pk_bf16_f32 v37, v74, v75
    v_cvt_pk_bf16_f32 v38, v76, v77
    v_cvt_pk_bf16_f32 v39, v78, v79
    buffer_store_dwordx4 v[32:35], v2, s[12:15], s70 offen offset:0 sc1
    buffer_store_dwordx4 v[36:39], v2, s[12:15], s70 offen offset:1024 sc1
    v_max_f32 v80, 0, v80
    v_max_f32 v81, 0, v81
    v_max_f32 v82, 0, v82
    v_max_f32 v83, 0, v83
    v_max_f32 v84, 0, v84
    v_max_f32 v85, 0, v85
    v_max_f32 v86, 0, v86
    v_max_f32 v87, 0, v87
    v_max_f32 v88, 0, v88
    v_max_f32 v89, 0, v89
    v_max_f32 v90, 0, v90
    v_max_f32 v91, 0, v91
    v_max_f32 v92, 0, v92
    v_max_f32 v93, 0, v93
    v_max_f32 v94, 0, v94
    v_max_f32 v95, 0, v95
    v_pk_mul_f32 v[80:81], v[80:81], v[112:113]
    v_pk_mul_f32 v[82:83], v[82:83], v[114:115]
    v_pk_mul_f32 v[84:85], v[84:85], v[116:117]
    v_pk_mul_f32 v[86:87], v[86:87], v[118:119]
    v_pk_mul_f32 v[88:89], v[88:89], v[120:121]
    v_pk_mul_f32 v[90:91], v[90:91], v[122:123]
    v_pk_mul_f32 v[92:93], v[92:93], v[124:125]
    v_pk_mul_f32 v[94:95], v[94:95], v[126:127]
    v_cvt_pk_bf16_f32 v40, v80, v81
    v_cvt_pk_bf16_f32 v41, v82, v83
    v_cvt_pk_bf16_f32 v42, v84, v85
    v_cvt_pk_bf16_f32 v43, v86, v87
    v_cvt_pk_bf16_f32 v44, v88, v89
    v_cvt_pk_bf16_f32 v45, v90, v91
    v_cvt_pk_bf16_f32 v46, v92, v93
    v_cvt_pk_bf16_f32 v47, v94, v95
    buffer_store_dwordx4 v[40:43], v2, s[12:15], s70 offen offset:2048 sc1
    buffer_store_dwordx4 v[44:47], v2, s[12:15], s70 offen offset:3072 sc1
Lj_28:
    s_waitcnt lgkmcnt(0)
    ds_read_b64_tr_b16 v[16:17], v3 offset:49152
    ds_read_b64_tr_b16 v[18:19], v3 offset:49664
    ds_read_b64_tr_b16 v[20:21], v4 offset:49152
    ds_read_b64_tr_b16 v[22:23], v4 offset:49664
    ds_read_b64_tr_b16 v[24:25], v3 offset:57344
    ds_read_b64_tr_b16 v[26:27], v3 offset:57856
    ds_read_b64_tr_b16 v[28:29], v4 offset:57344
    ds_read_b64_tr_b16 v[30:31], v4 offset:57856
    ds_read_b64_tr_b16 v[32:33], v3 offset:51200
    ds_read_b64_tr_b16 v[34:35], v3 offset:51712
    ds_read_b64_tr_b16 v[36:37], v4 offset:51200
    ds_read_b64_tr_b16 v[38:39], v4 offset:51712
    s_waitcnt lgkmcnt(8)
    v_mfma_f32_32x32x16_bf16 v[64:79], v[16:19], a[0:3], 0
    ds_read_b64_tr_b16 v[40:41], v3 offset:59392
    ds_read_b64_tr_b16 v[42:43], v3 offset:59904
    v_mfma_f32_32x32x16_bf16 v[80:95], v[20:23], a[0:3], 0
    ds_read_b64_tr_b16 v[44:45], v4 offset:59392
    ds_read_b64_tr_b16 v[46:47], v4 offset:59904
    s_waitcnt lgkmcnt(8)
    v_mfma_f32_32x32x16_bf16 v[96:111], v[24:27], a[0:3], 0
    ds_read_b64_tr_b16 v[16:17], v3 offset:53248
    ds_read_b64_tr_b16 v[18:19], v3 offset:53760
    v_mfma_f32_32x32x16_bf16 v[112:127], v[28:31], a[0:3], 0
    ds_read_b64_tr_b16 v[20:21], v4 offset:53248
    ds_read_b64_tr_b16 v[22:23], v4 offset:53760
    s_waitcnt lgkmcnt(8)
    v_mfma_f32_32x32x16_bf16 v[64:79], v[32:35], a[4:7], v[64:79]
    ds_read_b64_tr_b16 v[24:25], v3 offset:61440
    ds_read_b64_tr_b16 v[26:27], v3 offset:61952
    v_mfma_f32_32x32x16_bf16 v[80:95], v[36:39], a[4:7], v[80:95]
    ds_read_b64_tr_b16 v[28:29], v4 offset:61440
    ds_read_b64_tr_b16 v[30:31], v4 offset:61952
    s_waitcnt lgkmcnt(8)
    v_mfma_f32_32x32x16_bf16 v[96:111], v[40:43], a[4:7], v[96:111]
    ds_read_b64_tr_b16 v[32:33], v3 offset:55296
    ds_read_b64_tr_b16 v[34:35], v3 offset:55808
    v_mfma_f32_32x32x16_bf16 v[112:127], v[44:47], a[4:7], v[112:127]
    ds_read_b64_tr_b16 v[36:37], v4 offset:55296
    ds_read_b64_tr_b16 v[38:39], v4 offset:55808
    s_waitcnt lgkmcnt(8)
    v_mfma_f32_32x32x16_bf16 v[64:79], v[16:19], a[8:11], v[64:79]
    ds_read_b64_tr_b16 v[40:41], v3 offset:63488
    ds_read_b64_tr_b16 v[42:43], v3 offset:64000
    v_mfma_f32_32x32x16_bf16 v[80:95], v[20:23], a[8:11], v[80:95]
    s_waitcnt lgkmcnt(0)
    s_barrier
    ds_read_b64_tr_b16 v[44:45], v4 offset:63488
    ds_read_b64_tr_b16 v[46:47], v4 offset:64000
    v_mfma_f32_32x32x16_bf16 v[96:111], v[24:27], a[8:11], v[96:111]
    ds_read_b64_tr_b16 v[16:17], v5 offset:0
    ds_read_b64_tr_b16 v[18:19], v5 offset:512
    v_mfma_f32_32x32x16_bf16 v[112:127], v[28:31], a[8:11], v[112:127]
    ds_read_b64_tr_b16 v[20:21], v6 offset:0
    ds_read_b64_tr_b16 v[22:23], v6 offset:512
    v_mfma_f32_32x32x16_bf16 v[64:79], v[32:35], a[12:15], v[64:79]
    ds_read_b64_tr_b16 v[24:25], v5 offset:8192
    ds_read_b64_tr_b16 v[26:27], v5 offset:8704
    v_mfma_f32_32x32x16_bf16 v[80:95], v[36:39], a[12:15], v[80:95]
    ds_read_b64_tr_b16 v[28:29], v6 offset:8192
    ds_read_b64_tr_b16 v[30:31], v6 offset:8704
    s_waitcnt lgkmcnt(8)
    v_mfma_f32_32x32x16_bf16 v[96:111], v[40:43], a[12:15], v[96:111]
    ds_read_b64_tr_b16 v[32:33], v5 offset:2048
    ds_read_b64_tr_b16 v[34:35], v5 offset:2560
    v_mfma_f32_32x32x16_bf16 v[112:127], v[44:47], a[12:15], v[112:127]
    ds_read_b64_tr_b16 v[36:37], v6 offset:2048
    ds_read_b64_tr_b16 v[38:39], v6 offset:2560
    s_waitcnt lgkmcnt(8)
    v_mfma_f32_32x32x16_bf16 v[64:79], v[16:19], a[16:19], v[64:79]
    ds_read_b64_tr_b16 v[40:41], v5 offset:10240
    ds_read_b64_tr_b16 v[42:43], v5 offset:10752
    v_mfma_f32_32x32x16_bf16 v[80:95], v[20:23], a[16:19], v[80:95]
    ds_read_b64_tr_b16 v[44:45], v6 offset:10240
    ds_read_b64_tr_b16 v[46:47], v6 offset:10752
    s_waitcnt lgkmcnt(8)
    v_mfma_f32_32x32x16_bf16 v[96:111], v[24:27], a[16:19], v[96:111]
    ds_read_b64_tr_b16 v[16:17], v5 offset:4096
    ds_read_b64_tr_b16 v[18:19], v5 offset:4608
    v_mfma_f32_32x32x16_bf16 v[112:127], v[28:31], a[16:19], v[112:127]
    ds_read_b64_tr_b16 v[20:21], v6 offset:4096
    ds_read_b64_tr_b16 v[22:23], v6 offset:4608
    s_waitcnt lgkmcnt(8)
    v_mfma_f32_32x32x16_bf16 v[64:79], v[32:35], a[20:23], v[64:79]
    ds_read_b64_tr_b16 v[24:25], v5 offset:12288
    ds_read_b64_tr_b16 v[26:27], v5 offset:12800
    v_mfma_f32_32x32x16_bf16 v[80:95], v[36:39], a[20:23], v[80:95]
    ds_read_b64_tr_b16 v[28:29], v6 offset:12288
    ds_read_b64_tr_b16 v[30:31], v6 offset:12800
    s_waitcnt lgkmcnt(8)
    v_mfma_f32_32x32x16_bf16 v[96:111], v[40:43], a[20:23], v[96:111]
    ds_read_b64_tr_b16 v[32:33], v5 offset:6144
    ds_read_b64_tr_b16 v[34:35], v5 offset:6656
    v_mfma_f32_32x32x16_bf16 v[112:127], v[44:47], a[20:23], v[112:127]
    ds_read_b64_tr_b16 v[36:37], v6 offset:6144
    ds_read_b64_tr_b16 v[38:39], v6 offset:6656
    s_waitcnt lgkmcnt(8)
    v_mfma_f32_32x32x16_bf16 v[64:79], v[16:19], a[24:27], v[64:79]
    ds_read_b64_tr_b16 v[40:41], v5 offset:14336
    ds_read_b64_tr_b16 v[42:43], v5 offset:14848
    v_mfma_f32_32x32x16_bf16 v[80:95], v[20:23], a[24:27], v[80:95]
    s_waitcnt vmcnt(0)
    s_barrier
    ds_read_b64_tr_b16 v[44:45], v6 offset:14336
    ds_read_b64_tr_b16 v[46:47], v6 offset:14848
    s_waitcnt lgkmcnt(8)
    v_mfma_f32_32x32x16_bf16 v[96:111], v[24:27], a[24:27], v[96:111]
    ds_read_b64_tr_b16 v[16:17], v3 offset:0
    ds_read_b64_tr_b16 v[18:19], v3 offset:512
    v_mfma_f32_32x32x16_bf16 v[112:127], v[28:31], a[24:27], v[112:127]
    ds_read_b64_tr_b16 v[20:21], v4 offset:0
    ds_read_b64_tr_b16 v[22:23], v4 offset:512
    s_waitcnt lgkmcnt(8)
    v_mfma_f32_32x32x16_bf16 v[64:79], v[32:35], a[28:31], v[64:79]
    ds_read_b64_tr_b16 v[24:25], v3 offset:8192
    ds_read_b64_tr_b16 v[26:27], v3 offset:8704
    v_mfma_f32_32x32x16_bf16 v[80:95], v[36:39], a[28:31], v[80:95]
    ds_read_b64_tr_b16 v[28:29], v4 offset:8192
    ds_read_b64_tr_b16 v[30:31], v4 offset:8704
    s_waitcnt lgkmcnt(8)
    v_mfma_f32_32x32x16_bf16 v[96:111], v[40:43], a[28:31], v[96:111]
    ds_read_b64_tr_b16 v[32:33], v3 offset:2048
    ds_read_b64_tr_b16 v[34:35], v3 offset:2560
    v_mfma_f32_32x32x16_bf16 v[112:127], v[44:47], a[28:31], v[112:127]
    ds_read_b64_tr_b16 v[36:37], v4 offset:2048
    ds_read_b64_tr_b16 v[38:39], v4 offset:2560
    s_waitcnt lgkmcnt(8)
    v_mfma_f32_32x32x16_bf16 v[64:79], v[16:19], a[32:35], v[64:79]
    ds_read_b64_tr_b16 v[40:41], v3 offset:10240
    ds_read_b64_tr_b16 v[42:43], v3 offset:10752
    v_mfma_f32_32x32x16_bf16 v[80:95], v[20:23], a[32:35], v[80:95]
    ds_read_b64_tr_b16 v[44:45], v4 offset:10240
    ds_read_b64_tr_b16 v[46:47], v4 offset:10752
    s_waitcnt lgkmcnt(8)
    v_mfma_f32_32x32x16_bf16 v[96:111], v[24:27], a[32:35], v[96:111]
    ds_read_b64_tr_b16 v[16:17], v3 offset:4096
    ds_read_b64_tr_b16 v[18:19], v3 offset:4608
    v_mfma_f32_32x32x16_bf16 v[112:127], v[28:31], a[32:35], v[112:127]
    ds_read_b64_tr_b16 v[20:21], v4 offset:4096
    ds_read_b64_tr_b16 v[22:23], v4 offset:4608
    s_waitcnt lgkmcnt(8)
    v_mfma_f32_32x32x16_bf16 v[64:79], v[32:35], a[36:39], v[64:79]
    ds_read_b64_tr_b16 v[24:25], v3 offset:12288
    ds_read_b64_tr_b16 v[26:27], v3 offset:12800
    v_mfma_f32_32x32x16_bf16 v[80:95], v[36:39], a[36:39], v[80:95]
    ds_read_b64_tr_b16 v[28:29], v4 offset:12288
    ds_read_b64_tr_b16 v[30:31], v4 offset:12800
    s_waitcnt lgkmcnt(8)
    v_mfma_f32_32x32x16_bf16 v[96:111], v[40:43], a[36:39], v[96:111]
    ds_read_b64_tr_b16 v[32:33], v3 offset:6144
    ds_read_b64_tr_b16 v[34:35], v3 offset:6656
    v_mfma_f32_32x32x16_bf16 v[112:127], v[44:47], a[36:39], v[112:127]
    ds_read_b64_tr_b16 v[36:37], v4 offset:6144
    ds_read_b64_tr_b16 v[38:39], v4 offset:6656
    s_waitcnt lgkmcnt(8)
    v_mfma_f32_32x32x16_bf16 v[64:79], v[16:19], a[40:43], v[64:79]
    ds_read_b64_tr_b16 v[40:41], v3 offset:14336
    ds_read_b64_tr_b16 v[42:43], v3 offset:14848
    v_mfma_f32_32x32x16_bf16 v[80:95], v[20:23], a[40:43], v[80:95]
    s_barrier
    ds_read_b64_tr_b16 v[44:45], v4 offset:14336
    ds_read_b64_tr_b16 v[46:47], v4 offset:14848
    s_waitcnt lgkmcnt(8)
    v_mfma_f32_32x32x16_bf16 v[96:111], v[24:27], a[40:43], v[96:111]
    ds_read_b64_tr_b16 v[16:17], v3 offset:16384
    ds_read_b64_tr_b16 v[18:19], v3 offset:16896
    v_mfma_f32_32x32x16_bf16 v[112:127], v[28:31], a[40:43], v[112:127]
    ds_read_b64_tr_b16 v[20:21], v4 offset:16384
    ds_read_b64_tr_b16 v[22:23], v4 offset:16896
    s_waitcnt lgkmcnt(8)
    v_mfma_f32_32x32x16_bf16 v[64:79], v[32:35], a[44:47], v[64:79]
    ds_read_b64_tr_b16 v[24:25], v3 offset:24576
    ds_read_b64_tr_b16 v[26:27], v3 offset:25088
    v_mfma_f32_32x32x16_bf16 v[80:95], v[36:39], a[44:47], v[80:95]
    ds_read_b64_tr_b16 v[28:29], v4 offset:24576
    ds_read_b64_tr_b16 v[30:31], v4 offset:25088
    s_waitcnt lgkmcnt(8)
    v_mfma_f32_32x32x16_bf16 v[96:111], v[40:43], a[44:47], v[96:111]
    ds_read_b64_tr_b16 v[32:33], v3 offset:18432
    ds_read_b64_tr_b16 v[34:35], v3 offset:18944
    v_mfma_f32_32x32x16_bf16 v[112:127], v[44:47], a[44:47], v[112:127]
    ds_read_b64_tr_b16 v[36:37], v4 offset:18432
    ds_read_b64_tr_b16 v[38:39], v4 offset:18944
    s_waitcnt lgkmcnt(8)
    v_mfma_f32_32x32x16_bf16 v[64:79], v[16:19], a[48:51], v[64:79]
    ds_read_b64_tr_b16 v[40:41], v3 offset:26624
    ds_read_b64_tr_b16 v[42:43], v3 offset:27136
    v_mfma_f32_32x32x16_bf16 v[80:95], v[20:23], a[48:51], v[80:95]
    ds_read_b64_tr_b16 v[44:45], v4 offset:26624
    ds_read_b64_tr_b16 v[46:47], v4 offset:27136
    s_waitcnt lgkmcnt(8)
    v_mfma_f32_32x32x16_bf16 v[96:111], v[24:27], a[48:51], v[96:111]
    ds_read_b64_tr_b16 v[16:17], v3 offset:20480
    ds_read_b64_tr_b16 v[18:19], v3 offset:20992
    v_mfma_f32_32x32x16_bf16 v[112:127], v[28:31], a[48:51], v[112:127]
    ds_read_b64_tr_b16 v[20:21], v4 offset:20480
    ds_read_b64_tr_b16 v[22:23], v4 offset:20992
    s_waitcnt lgkmcnt(8)
    v_mfma_f32_32x32x16_bf16 v[64:79], v[32:35], a[52:55], v[64:79]
    ds_read_b64_tr_b16 v[24:25], v3 offset:28672
    ds_read_b64_tr_b16 v[26:27], v3 offset:29184
    v_mfma_f32_32x32x16_bf16 v[80:95], v[36:39], a[52:55], v[80:95]
    ds_read_b64_tr_b16 v[28:29], v4 offset:28672
    ds_read_b64_tr_b16 v[30:31], v4 offset:29184
    s_waitcnt lgkmcnt(8)
    v_mfma_f32_32x32x16_bf16 v[96:111], v[40:43], a[52:55], v[96:111]
    ds_read_b64_tr_b16 v[32:33], v3 offset:22528
    ds_read_b64_tr_b16 v[34:35], v3 offset:23040
    v_mfma_f32_32x32x16_bf16 v[112:127], v[44:47], a[52:55], v[112:127]
    ds_read_b64_tr_b16 v[36:37], v4 offset:22528
    ds_read_b64_tr_b16 v[38:39], v4 offset:23040
    s_waitcnt lgkmcnt(8)
    v_mfma_f32_32x32x16_bf16 v[64:79], v[16:19], a[56:59], v[64:79]
    ds_read_b64_tr_b16 v[40:41], v3 offset:30720
    ds_read_b64_tr_b16 v[42:43], v3 offset:31232
    v_mfma_f32_32x32x16_bf16 v[80:95], v[20:23], a[56:59], v[80:95]
    s_barrier
    ds_read_b64_tr_b16 v[44:45], v4 offset:30720
    ds_read_b64_tr_b16 v[46:47], v4 offset:31232
    s_waitcnt lgkmcnt(8)
    v_mfma_f32_32x32x16_bf16 v[96:111], v[24:27], a[56:59], v[96:111]
    ds_read_b64_tr_b16 v[16:17], v3 offset:32768
    ds_read_b64_tr_b16 v[18:19], v3 offset:33280
    v_mfma_f32_32x32x16_bf16 v[112:127], v[28:31], a[56:59], v[112:127]
    ds_read_b64_tr_b16 v[20:21], v4 offset:32768
    ds_read_b64_tr_b16 v[22:23], v4 offset:33280
    s_waitcnt lgkmcnt(8)
    v_mfma_f32_32x32x16_bf16 v[64:79], v[32:35], a[60:63], v[64:79]
    ds_read_b64_tr_b16 v[24:25], v3 offset:40960
    ds_read_b64_tr_b16 v[26:27], v3 offset:41472
    v_mfma_f32_32x32x16_bf16 v[80:95], v[36:39], a[60:63], v[80:95]
    ds_read_b64_tr_b16 v[28:29], v4 offset:40960
    ds_read_b64_tr_b16 v[30:31], v4 offset:41472
    s_waitcnt lgkmcnt(8)
    v_mfma_f32_32x32x16_bf16 v[96:111], v[40:43], a[60:63], v[96:111]
    ds_read_b64_tr_b16 v[32:33], v3 offset:34816
    ds_read_b64_tr_b16 v[34:35], v3 offset:35328
    v_mfma_f32_32x32x16_bf16 v[112:127], v[44:47], a[60:63], v[112:127]
    ds_read_b64_tr_b16 v[36:37], v4 offset:34816
    ds_read_b64_tr_b16 v[38:39], v4 offset:35328
    s_waitcnt lgkmcnt(8)
    v_mfma_f32_32x32x16_bf16 v[64:79], v[16:19], a[64:67], v[64:79]
    ds_read_b64_tr_b16 v[40:41], v3 offset:43008
    ds_read_b64_tr_b16 v[42:43], v3 offset:43520
    v_mfma_f32_32x32x16_bf16 v[80:95], v[20:23], a[64:67], v[80:95]
    ds_read_b64_tr_b16 v[44:45], v4 offset:43008
    ds_read_b64_tr_b16 v[46:47], v4 offset:43520
    s_waitcnt lgkmcnt(8)
    v_mfma_f32_32x32x16_bf16 v[96:111], v[24:27], a[64:67], v[96:111]
    ds_read_b64_tr_b16 v[16:17], v3 offset:36864
    ds_read_b64_tr_b16 v[18:19], v3 offset:37376
    v_mfma_f32_32x32x16_bf16 v[112:127], v[28:31], a[64:67], v[112:127]
    ds_read_b64_tr_b16 v[20:21], v4 offset:36864
    ds_read_b64_tr_b16 v[22:23], v4 offset:37376
    s_waitcnt lgkmcnt(8)
    v_mfma_f32_32x32x16_bf16 v[64:79], v[32:35], a[68:71], v[64:79]
    ds_read_b64_tr_b16 v[24:25], v3 offset:45056
    ds_read_b64_tr_b16 v[26:27], v3 offset:45568
    v_mfma_f32_32x32x16_bf16 v[80:95], v[36:39], a[68:71], v[80:95]
    ds_read_b64_tr_b16 v[28:29], v4 offset:45056
    ds_read_b64_tr_b16 v[30:31], v4 offset:45568
    s_waitcnt lgkmcnt(8)
    v_mfma_f32_32x32x16_bf16 v[96:111], v[40:43], a[68:71], v[96:111]
    ds_read_b64_tr_b16 v[32:33], v3 offset:38912
    ds_read_b64_tr_b16 v[34:35], v3 offset:39424
    v_mfma_f32_32x32x16_bf16 v[112:127], v[44:47], a[68:71], v[112:127]
    ds_read_b64_tr_b16 v[36:37], v4 offset:38912
    ds_read_b64_tr_b16 v[38:39], v4 offset:39424
    s_waitcnt lgkmcnt(8)
    v_mfma_f32_32x32x16_bf16 v[64:79], v[16:19], a[72:75], v[64:79]
    ds_read_b64_tr_b16 v[40:41], v3 offset:47104
    ds_read_b64_tr_b16 v[42:43], v3 offset:47616
    v_mfma_f32_32x32x16_bf16 v[80:95], v[20:23], a[72:75], v[80:95]
    s_barrier
    ds_read_b64_tr_b16 v[44:45], v4 offset:47104
    ds_read_b64_tr_b16 v[46:47], v4 offset:47616
    s_waitcnt lgkmcnt(8)
    v_mfma_f32_32x32x16_bf16 v[96:111], v[24:27], a[72:75], v[96:111]
    ds_read_b64_tr_b16 v[16:17], v3 offset:49152
    ds_read_b64_tr_b16 v[18:19], v3 offset:49664
    v_mfma_f32_32x32x16_bf16 v[112:127], v[28:31], a[72:75], v[112:127]
    ds_read_b64_tr_b16 v[20:21], v4 offset:49152
    ds_read_b64_tr_b16 v[22:23], v4 offset:49664
    s_waitcnt lgkmcnt(8)
    v_mfma_f32_32x32x16_bf16 v[64:79], v[32:35], a[76:79], v[64:79]
    ds_read_b64_tr_b16 v[24:25], v3 offset:57344
    ds_read_b64_tr_b16 v[26:27], v3 offset:57856
    v_mfma_f32_32x32x16_bf16 v[80:95], v[36:39], a[76:79], v[80:95]
    ds_read_b64_tr_b16 v[28:29], v4 offset:57344
    ds_read_b64_tr_b16 v[30:31], v4 offset:57856
    s_waitcnt lgkmcnt(8)
    v_mfma_f32_32x32x16_bf16 v[96:111], v[40:43], a[76:79], v[96:111]
    ds_read_b64_tr_b16 v[32:33], v3 offset:51200
    ds_read_b64_tr_b16 v[34:35], v3 offset:51712
    v_mfma_f32_32x32x16_bf16 v[112:127], v[44:47], a[76:79], v[112:127]
    ds_read_b64_tr_b16 v[36:37], v4 offset:51200
    ds_read_b64_tr_b16 v[38:39], v4 offset:51712
    s_waitcnt lgkmcnt(8)
    v_mfma_f32_32x32x16_bf16 v[64:79], v[16:19], a[80:83], v[64:79]
    ds_read_b64_tr_b16 v[40:41], v3 offset:59392
    ds_read_b64_tr_b16 v[42:43], v3 offset:59904
    v_mfma_f32_32x32x16_bf16 v[80:95], v[20:23], a[80:83], v[80:95]
    ds_read_b64_tr_b16 v[44:45], v4 offset:59392
    ds_read_b64_tr_b16 v[46:47], v4 offset:59904
    s_waitcnt lgkmcnt(8)
    v_mfma_f32_32x32x16_bf16 v[96:111], v[24:27], a[80:83], v[96:111]
    ds_read_b64_tr_b16 v[16:17], v3 offset:53248
    ds_read_b64_tr_b16 v[18:19], v3 offset:53760
    v_mfma_f32_32x32x16_bf16 v[112:127], v[28:31], a[80:83], v[112:127]
    ds_read_b64_tr_b16 v[20:21], v4 offset:53248
    ds_read_b64_tr_b16 v[22:23], v4 offset:53760
    s_waitcnt lgkmcnt(8)
    v_mfma_f32_32x32x16_bf16 v[64:79], v[32:35], a[84:87], v[64:79]
    ds_read_b64_tr_b16 v[24:25], v3 offset:61440
    ds_read_b64_tr_b16 v[26:27], v3 offset:61952
    v_mfma_f32_32x32x16_bf16 v[80:95], v[36:39], a[84:87], v[80:95]
    ds_read_b64_tr_b16 v[28:29], v4 offset:61440
    ds_read_b64_tr_b16 v[30:31], v4 offset:61952
    s_waitcnt lgkmcnt(8)
    v_mfma_f32_32x32x16_bf16 v[96:111], v[40:43], a[84:87], v[96:111]
    ds_read_b64_tr_b16 v[32:33], v3 offset:55296
    ds_read_b64_tr_b16 v[34:35], v3 offset:55808
    v_mfma_f32_32x32x16_bf16 v[112:127], v[44:47], a[84:87], v[112:127]
    ds_read_b64_tr_b16 v[36:37], v4 offset:55296
    ds_read_b64_tr_b16 v[38:39], v4 offset:55808
    s_waitcnt lgkmcnt(8)
    v_mfma_f32_32x32x16_bf16 v[64:79], v[16:19], a[88:91], v[64:79]
    ds_read_b64_tr_b16 v[40:41], v3 offset:63488
    ds_read_b64_tr_b16 v[42:43], v3 offset:64000
    v_mfma_f32_32x32x16_bf16 v[80:95], v[20:23], a[88:91], v[80:95]
    s_barrier
    ds_read_b64_tr_b16 v[44:45], v4 offset:63488
    ds_read_b64_tr_b16 v[46:47], v4 offset:64000
    s_waitcnt lgkmcnt(8)
    v_mfma_f32_32x32x16_bf16 v[96:111], v[24:27], a[88:91], v[96:111]
    ds_read_b64_tr_b16 v[16:17], v5 offset:0
    ds_read_b64_tr_b16 v[18:19], v5 offset:512
    v_mfma_f32_32x32x16_bf16 v[112:127], v[28:31], a[88:91], v[112:127]
    ds_read_b64_tr_b16 v[20:21], v6 offset:0
    ds_read_b64_tr_b16 v[22:23], v6 offset:512
    s_waitcnt lgkmcnt(8)
    v_mfma_f32_32x32x16_bf16 v[64:79], v[32:35], a[92:95], v[64:79]
    ds_read_b64_tr_b16 v[24:25], v5 offset:8192
    ds_read_b64_tr_b16 v[26:27], v5 offset:8704
    v_mfma_f32_32x32x16_bf16 v[80:95], v[36:39], a[92:95], v[80:95]
    ds_read_b64_tr_b16 v[28:29], v6 offset:8192
    ds_read_b64_tr_b16 v[30:31], v6 offset:8704
    s_waitcnt lgkmcnt(8)
    v_mfma_f32_32x32x16_bf16 v[96:111], v[40:43], a[92:95], v[96:111]
    ds_read_b64_tr_b16 v[32:33], v5 offset:2048
    ds_read_b64_tr_b16 v[34:35], v5 offset:2560
    v_mfma_f32_32x32x16_bf16 v[112:127], v[44:47], a[92:95], v[112:127]
    ds_read_b64_tr_b16 v[36:37], v6 offset:2048
    ds_read_b64_tr_b16 v[38:39], v6 offset:2560
    s_waitcnt lgkmcnt(8)
    v_mfma_f32_32x32x16_bf16 v[64:79], v[16:19], a[96:99], v[64:79]
    ds_read_b64_tr_b16 v[40:41], v5 offset:10240
    ds_read_b64_tr_b16 v[42:43], v5 offset:10752
    v_mfma_f32_32x32x16_bf16 v[80:95], v[20:23], a[96:99], v[80:95]
    ds_read_b64_tr_b16 v[44:45], v6 offset:10240
    ds_read_b64_tr_b16 v[46:47], v6 offset:10752
    s_waitcnt lgkmcnt(8)
    v_mfma_f32_32x32x16_bf16 v[96:111], v[24:27], a[96:99], v[96:111]
    ds_read_b64_tr_b16 v[16:17], v5 offset:4096
    ds_read_b64_tr_b16 v[18:19], v5 offset:4608
    v_mfma_f32_32x32x16_bf16 v[112:127], v[28:31], a[96:99], v[112:127]
    ds_read_b64_tr_b16 v[20:21], v6 offset:4096
    ds_read_b64_tr_b16 v[22:23], v6 offset:4608
    s_waitcnt lgkmcnt(8)
    v_mfma_f32_32x32x16_bf16 v[64:79], v[32:35], a[100:103], v[64:79]
    ds_read_b64_tr_b16 v[24:25], v5 offset:12288
    ds_read_b64_tr_b16 v[26:27], v5 offset:12800
    v_mfma_f32_32x32x16_bf16 v[80:95], v[36:39], a[100:103], v[80:95]
    ds_read_b64_tr_b16 v[28:29], v6 offset:12288
    ds_read_b64_tr_b16 v[30:31], v6 offset:12800
    s_waitcnt lgkmcnt(8)
    v_mfma_f32_32x32x16_bf16 v[96:111], v[40:43], a[100:103], v[96:111]
    ds_read_b64_tr_b16 v[32:33], v5 offset:6144
    ds_read_b64_tr_b16 v[34:35], v5 offset:6656
    v_mfma_f32_32x32x16_bf16 v[112:127], v[44:47], a[100:103], v[112:127]
    ds_read_b64_tr_b16 v[36:37], v6 offset:6144
    ds_read_b64_tr_b16 v[38:39], v6 offset:6656
    s_waitcnt lgkmcnt(8)
    v_mfma_f32_32x32x16_bf16 v[64:79], v[16:19], a[104:107], v[64:79]
    ds_read_b64_tr_b16 v[40:41], v5 offset:14336
    ds_read_b64_tr_b16 v[42:43], v5 offset:14848
    v_mfma_f32_32x32x16_bf16 v[80:95], v[20:23], a[104:107], v[80:95]
    s_barrier
    ds_read_b64_tr_b16 v[44:45], v6 offset:14336
    ds_read_b64_tr_b16 v[46:47], v6 offset:14848
    s_waitcnt lgkmcnt(8)
    v_mfma_f32_32x32x16_bf16 v[96:111], v[24:27], a[104:107], v[96:111]
    ds_read_b64_tr_b16 v[16:17], v3 offset:0
    ds_read_b64_tr_b16 v[18:19], v3 offset:512
    v_mfma_f32_32x32x16_bf16 v[112:127], v[28:31], a[104:107], v[112:127]
    ds_read_b64_tr_b16 v[20:21], v4 offset:0
    ds_read_b64_tr_b16 v[22:23], v4 offset:512
    s_waitcnt lgkmcnt(8)
    v_mfma_f32_32x32x16_bf16 v[64:79], v[32:35], a[108:111], v[64:79]
    ds_read_b64_tr_b16 v[24:25], v3 offset:8192
    ds_read_b64_tr_b16 v[26:27], v3 offset:8704
    v_mfma_f32_32x32x16_bf16 v[80:95], v[36:39], a[108:111], v[80:95]
    ds_read_b64_tr_b16 v[28:29], v4 offset:8192
    ds_read_b64_tr_b16 v[30:31], v4 offset:8704
    s_waitcnt lgkmcnt(8)
    v_mfma_f32_32x32x16_bf16 v[96:111], v[40:43], a[108:111], v[96:111]
    ds_read_b64_tr_b16 v[32:33], v3 offset:2048
    ds_read_b64_tr_b16 v[34:35], v3 offset:2560
    v_mfma_f32_32x32x16_bf16 v[112:127], v[44:47], a[108:111], v[112:127]
    ds_read_b64_tr_b16 v[36:37], v4 offset:2048
    ds_read_b64_tr_b16 v[38:39], v4 offset:2560
    s_waitcnt lgkmcnt(8)
    v_mfma_f32_32x32x16_bf16 v[64:79], v[16:19], a[112:115], v[64:79]
    ds_read_b64_tr_b16 v[40:41], v3 offset:10240
    ds_read_b64_tr_b16 v[42:43], v3 offset:10752
    v_mfma_f32_32x32x16_bf16 v[80:95], v[20:23], a[112:115], v[80:95]
    ds_read_b64_tr_b16 v[44:45], v4 offset:10240
    ds_read_b64_tr_b16 v[46:47], v4 offset:10752
    s_waitcnt lgkmcnt(8)
    v_mfma_f32_32x32x16_bf16 v[96:111], v[24:27], a[112:115], v[96:111]
    ds_read_b64_tr_b16 v[16:17], v3 offset:4096
    ds_read_b64_tr_b16 v[18:19], v3 offset:4608
    v_mfma_f32_32x32x16_bf16 v[112:127], v[28:31], a[112:115], v[112:127]
    ds_read_b64_tr_b16 v[20:21], v4 offset:4096
    ds_read_b64_tr_b16 v[22:23], v4 offset:4608
    s_waitcnt lgkmcnt(8)
    v_mfma_f32_32x32x16_bf16 v[64:79], v[32:35], a[116:119], v[64:79]
    ds_read_b64_tr_b16 v[24:25], v3 offset:12288
    ds_read_b64_tr_b16 v[26:27], v3 offset:12800
    v_mfma_f32_32x32x16_bf16 v[80:95], v[36:39], a[116:119], v[80:95]
    ds_read_b64_tr_b16 v[28:29], v4 offset:12288
    ds_read_b64_tr_b16 v[30:31], v4 offset:12800
    s_waitcnt lgkmcnt(8)
    v_mfma_f32_32x32x16_bf16 v[96:111], v[40:43], a[116:119], v[96:111]
    ds_read_b64_tr_b16 v[32:33], v3 offset:6144
    ds_read_b64_tr_b16 v[34:35], v3 offset:6656
    v_mfma_f32_32x32x16_bf16 v[112:127], v[44:47], a[116:119], v[112:127]
    ds_read_b64_tr_b16 v[36:37], v4 offset:6144
    ds_read_b64_tr_b16 v[38:39], v4 offset:6656
    s_waitcnt lgkmcnt(8)
    v_mfma_f32_32x32x16_bf16 v[64:79], v[16:19], a[120:123], v[64:79]
    ds_read_b64_tr_b16 v[40:41], v3 offset:14336
    ds_read_b64_tr_b16 v[42:43], v3 offset:14848
    v_mfma_f32_32x32x16_bf16 v[80:95], v[20:23], a[120:123], v[80:95]
    s_barrier
    ds_read_b64_tr_b16 v[44:45], v4 offset:14336
    ds_read_b64_tr_b16 v[46:47], v4 offset:14848
    s_waitcnt lgkmcnt(8)
    v_mfma_f32_32x32x16_bf16 v[96:111], v[24:27], a[120:123], v[96:111]
    v_mfma_f32_32x32x16_bf16 v[112:127], v[28:31], a[120:123], v[112:127]
    s_waitcnt lgkmcnt(4)
    v_mfma_f32_32x32x16_bf16 v[64:79], v[32:35], a[124:127], v[64:79]
    v_mfma_f32_32x32x16_bf16 v[80:95], v[36:39], a[124:127], v[80:95]
    s_waitcnt lgkmcnt(0)
    v_mfma_f32_32x32x16_bf16 v[96:111], v[40:43], a[124:127], v[96:111]
    v_mfma_f32_32x32x16_bf16 v[112:127], v[44:47], a[124:127], v[112:127]
    ds_read_b32 v16, v48 offset:512
    ds_read_b32 v17, v48 offset:512
    v_mov_b32 v18, 0
    v_mov_b32 v19, 0
    ds_read_b32 v20, v48 offset:640
    ds_read_b32 v21, v48 offset:640
    v_mov_b32 v22, 0
    v_mov_b32 v23, 0
    ds_read_b32 v24, v48 offset:768
    ds_read_b32 v25, v48 offset:768
    v_mov_b32 v26, 0
    v_mov_b32 v27, 0
    ds_read_b32 v28, v48 offset:896
    ds_read_b32 v29, v48 offset:896
    v_mov_b32 v30, 0
    v_mov_b32 v31, 0
    s_waitcnt lgkmcnt(6)
    v_mfma_f32_32x32x16_bf16 v[64:79], v[16:19], v[52:55], v[64:79]
    s_waitcnt lgkmcnt(4)
    v_mfma_f32_32x32x16_bf16 v[80:95], v[20:23], v[52:55], v[80:95]
    s_waitcnt lgkmcnt(2)
    v_mfma_f32_32x32x16_bf16 v[96:111], v[24:27], v[52:55], v[96:111]
    s_waitcnt lgkmcnt(0)
    v_mfma_f32_32x32x16_bf16 v[112:127], v[28:31], v[52:55], v[112:127]
    s_lshl_b32 s6, s49, 1
    s_add_u32 s6, s6, 9
    s_cmp_eq_u32 s50, 0
    s_cselect_b32 s6, s49, s6
    s_mul_i32 s7, s47, 36
    s_add_u32 s7, s7, s6
    s_lshl_b32 s7, s7, 2
    s_add_u32 s7, s7, s46
    s_lshl_b32 s7, s7, 12
    s_add_u32 s70, s7, 1048576
    v_max_f32 v64, 0, v64
    v_max_f32 v65, 0, v65
    v_max_f32 v66, 0, v66
    v_max_f32 v67, 0, v67
    v_max_f32 v68, 0, v68
    v_max_f32 v69, 0, v69
    v_max_f32 v70, 0, v70
    v_max_f32 v71, 0, v71
    v_max_f32 v72, 0, v72
    v_max_f32 v73, 0, v73
    v_max_f32 v74, 0, v74
    v_max_f32 v75, 0, v75
    v_max_f32 v76, 0, v76
    v_max_f32 v77, 0, v77
    v_max_f32 v78, 0, v78
    v_max_f32 v79, 0, v79
    v_pk_mul_f32 v[64:65], v[64:65], v[96:97]
    v_pk_mul_f32 v[66:67], v[66:67], v[98:99]
    v_pk_mul_f32 v[68:69], v[68:69], v[100:101]
    v_pk_mul_f32 v[70:71], v[70:71], v[102:103]
    v_pk_mul_f32 v[72:73], v[72:73], v[104:105]
    v_pk_mul_f32 v[74:75], v[74:75], v[106:107]
    v_pk_mul_f32 v[76:77], v[76:77], v[108:109]
    v_pk_mul_f32 v[78:79], v[78:79], v[110:111]
    v_cvt_pk_bf16_f32 v32, v64, v65
    v_cvt_pk_bf16_f32 v33, v66, v67
    v_cvt_pk_bf16_f32 v34, v68, v69
    v_cvt_pk_bf16_f32 v35, v70, v71
    v_cvt_pk_bf16_f32 v36, v72, v73
    v_cvt_pk_bf16_f32 v37, v74, v75
    v_cvt_pk_bf16_f32 v38, v76, v77
    v_cvt_pk_bf16_f32 v39, v78, v79
    buffer_store_dwordx4 v[32:35], v2, s[12:15], s70 offen offset:0 sc1
    buffer_store_dwordx4 v[36:39], v2, s[12:15], s70 offen offset:1024 sc1
    v_max_f32 v80, 0, v80
    v_max_f32 v81, 0, v81
    v_max_f32 v82, 0, v82
    v_max_f32 v83, 0, v83
    v_max_f32 v84, 0, v84
    v_max_f32 v85, 0, v85
    v_max_f32 v86, 0, v86
    v_max_f32 v87, 0, v87
    v_max_f32 v88, 0, v88
    v_max_f32 v89, 0, v89
    v_max_f32 v90, 0, v90
    v_max_f32 v91, 0, v91
    v_max_f32 v92, 0, v92
    v_max_f32 v93, 0, v93
    v_max_f32 v94, 0, v94
    v_max_f32 v95, 0, v95
    v_pk_mul_f32 v[80:81], v[80:81], v[112:113]
    v_pk_mul_f32 v[82:83], v[82:83], v[114:115]
    v_pk_mul_f32 v[84:85], v[84:85], v[116:117]
    v_pk_mul_f32 v[86:87], v[86:87], v[118:119]
    v_pk_mul_f32 v[88:89], v[88:89], v[120:121]
    v_pk_mul_f32 v[90:91], v[90:91], v[122:123]
    v_pk_mul_f32 v[92:93], v[92:93], v[124:125]
    v_pk_mul_f32 v[94:95], v[94:95], v[126:127]
    v_cvt_pk_bf16_f32 v40, v80, v81
    v_cvt_pk_bf16_f32 v41, v82, v83
    v_cvt_pk_bf16_f32 v42, v84, v85
    v_cvt_pk_bf16_f32 v43, v86, v87
    v_cvt_pk_bf16_f32 v44, v88, v89
    v_cvt_pk_bf16_f32 v45, v90, v91
    v_cvt_pk_bf16_f32 v46, v92, v93
    v_cvt_pk_bf16_f32 v47, v94, v95
    buffer_store_dwordx4 v[40:43], v2, s[12:15], s70 offen offset:2048 sc1
    buffer_store_dwordx4 v[44:47], v2, s[12:15], s70 offen offset:3072 sc1
    ds_read_b64_tr_b16 v[16:17], v7 offset:16384
    ds_read_b64_tr_b16 v[18:19], v7 offset:16640
    ds_read_b64_tr_b16 v[20:21], v7 offset:24576
    ds_read_b64_tr_b16 v[22:23], v7 offset:24832
    ds_read_b64_tr_b16 v[24:25], v7 offset:17408
    ds_read_b64_tr_b16 v[26:27], v7 offset:17664
    ds_read_b64_tr_b16 v[28:29], v7 offset:25600
    ds_read_b64_tr_b16 v[30:31], v7 offset:25856
    ds_read_b64_tr_b16 v[32:33], v7 offset:18432
    ds_read_b64_tr_b16 v[34:35], v7 offset:18688
    ds_read_b64_tr_b16 v[36:37], v7 offset:26624
    ds_read_b64_tr_b16 v[38:39], v7 offset:26880
    s_waitcnt lgkmcnt(8)
    v_mfma_f32_32x32x16_bf16 v[64:79], v[16:19], a[0:3], 0
    ds_read_b64_tr_b16 v[40:41], v7 offset:19456
    ds_read_b64_tr_b16 v[42:43], v7 offset:19712
    v_mfma_f32_32x32x16_bf16 v[80:95], v[20:23], a[0:3], 0
    ds_read_b64_tr_b16 v[44:45], v7 offset:27648
    ds_read_b64_tr_b16 v[46:47], v7 offset:27904
    s_waitcnt lgkmcnt(8)
    v_mfma_f32_32x32x16_bf16 v[64:79], v[24:27], a[4:7], v[64:79]
    ds_read_b64_tr_b16 v[16:17], v7 offset:20480
    ds_read_b64_tr_b16 v[18:19], v7 offset:20736
    v_mfma_f32_32x32x16_bf16 v[80:95], v[28:31], a[4:7], v[80:95]
    ds_read_b64_tr_b16 v[20:21], v7 offset:28672
    ds_read_b64_tr_b16 v[22:23], v7 offset:28928
    s_waitcnt lgkmcnt(8)
    v_mfma_f32_32x32x16_bf16 v[64:79], v[32:35], a[8:11], v[64:79]
    ds_read_b64_tr_b16 v[24:25], v7 offset:21504
    ds_read_b64_tr_b16 v[26:27], v7 offset:21760
    v_mfma_f32_32x32x16_bf16 v[80:95], v[36:39], a[8:11], v[80:95]
    ds_read_b64_tr_b16 v[28:29], v7 offset:29696
    ds_read_b64_tr_b16 v[30:31], v7 offset:29952
    s_waitcnt lgkmcnt(8)
    v_mfma_f32_32x32x16_bf16 v[64:79], v[40:43], a[12:15], v[64:79]
    ds_read_b64_tr_b16 v[32:33], v7 offset:22528
    ds_read_b64_tr_b16 v[34:35], v7 offset:22784
    v_mfma_f32_32x32x16_bf16 v[80:95], v[44:47], a[12:15], v[80:95]
    ds_read_b64_tr_b16 v[36:37], v7 offset:30720
    ds_read_b64_tr_b16 v[38:39], v7 offset:30976
    s_waitcnt lgkmcnt(8)
    v_mfma_f32_32x32x16_bf16 v[64:79], v[16:19], a[16:19], v[64:79]
    ds_read_b64_tr_b16 v[40:41], v7 offset:23552
    ds_read_b64_tr_b16 v[42:43], v7 offset:23808
    v_mfma_f32_32x32x16_bf16 v[80:95], v[20:23], a[16:19], v[80:95]
    s_barrier
    ds_read_b64_tr_b16 v[44:45], v7 offset:31744
    ds_read_b64_tr_b16 v[46:47], v7 offset:32000
    s_waitcnt lgkmcnt(8)
    v_mfma_f32_32x32x16_bf16 v[64:79], v[24:27], a[20:23], v[64:79]
    ds_read_b64_tr_b16 v[16:17], v7 offset:32768
    ds_read_b64_tr_b16 v[18:19], v7 offset:33024
    v_mfma_f32_32x32x16_bf16 v[80:95], v[28:31], a[20:23], v[80:95]
    ds_read_b64_tr_b16 v[20:21], v7 offset:40960
    ds_read_b64_tr_b16 v[22:23], v7 offset:41216
    s_waitcnt lgkmcnt(8)
    v_mfma_f32_32x32x16_bf16 v[64:79], v[32:35], a[24:27], v[64:79]
    ds_read_b64_tr_b16 v[24:25], v7 offset:33792
    ds_read_b64_tr_b16 v[26:27], v7 offset:34048
    v_mfma_f32_32x32x16_bf16 v[80:95], v[36:39], a[24:27], v[80:95]
    ds_read_b64_tr_b16 v[28:29], v7 offset:41984
    ds_read_b64_tr_b16 v[30:31], v7 offset:42240
    s_waitcnt lgkmcnt(8)
    v_mfma_f32_32x32x16_bf16 v[64:79], v[40:43], a[28:31], v[64:79]
    ds_read_b64_tr_b16 v[32:33], v7 offset:34816
    ds_read_b64_tr_b16 v[34:35], v7 offset:35072
    v_mfma_f32_32x32x16_bf16 v[80:95], v[44:47], a[28:31], v[80:95]
    ds_read_b64_tr_b16 v[36:37], v7 offset:43008
    ds_read_b64_tr_b16 v[38:39], v7 offset:43264
    s_waitcnt lgkmcnt(8)
    v_mfma_f32_32x32x16_bf16 v[64:79], v[16:19], a[32:35], v[64:79]
    ds_read_b64_tr_b16 v[40:41], v7 offset:35840
    ds_read_b64_tr_b16 v[42:43], v7 offset:36096
    v_mfma_f32_32x32x16_bf16 v[80:95], v[20:23], a[32:35], v[80:95]
    ds_read_b64_tr_b16 v[44:45], v7 offset:44032
    ds_read_b64_tr_b16 v[46:47], v7 offset:44288
    s_waitcnt lgkmcnt(8)
    v_mfma_f32_32x32x16_bf16 v[64:79], v[24:27], a[36:39], v[64:79]
    ds_read_b64_tr_b16 v[16:17], v7 offset:36864
    ds_read_b64_tr_b16 v[18:19], v7 offset:37120
    v_mfma_f32_32x32x16_bf16 v[80:95], v[28:31], a[36:39], v[80:95]
    ds_read_b64_tr_b16 v[20:21], v7 offset:45056
    ds_read_b64_tr_b16 v[22:23], v7 offset:45312
    s_waitcnt lgkmcnt(8)
    v_mfma_f32_32x32x16_bf16 v[64:79], v[32:35], a[40:43], v[64:79]
    ds_read_b64_tr_b16 v[24:25], v7 offset:37888
    ds_read_b64_tr_b16 v[26:27], v7 offset:38144
    v_mfma_f32_32x32x16_bf16 v[80:95], v[36:39], a[40:43], v[80:95]
    ds_read_b64_tr_b16 v[28:29], v7 offset:46080
    ds_read_b64_tr_b16 v[30:31], v7 offset:46336
    s_waitcnt lgkmcnt(8)
    v_mfma_f32_32x32x16_bf16 v[64:79], v[40:43], a[44:47], v[64:79]
    ds_read_b64_tr_b16 v[32:33], v7 offset:38912
    ds_read_b64_tr_b16 v[34:35], v7 offset:39168
    v_mfma_f32_32x32x16_bf16 v[80:95], v[44:47], a[44:47], v[80:95]
    ds_read_b64_tr_b16 v[36:37], v7 offset:47104
    ds_read_b64_tr_b16 v[38:39], v7 offset:47360
    s_waitcnt lgkmcnt(8)
    v_mfma_f32_32x32x16_bf16 v[64:79], v[16:19], a[48:51], v[64:79]
    ds_read_b64_tr_b16 v[40:41], v7 offset:39936
    ds_read_b64_tr_b16 v[42:43], v7 offset:40192
    v_mfma_f32_32x32x16_bf16 v[80:95], v[20:23], a[48:51], v[80:95]
    s_waitcnt vmcnt(0)
    s_barrier
    ds_read_b64_tr_b16 v[44:45], v7 offset:48128
    ds_read_b64_tr_b16 v[46:47], v7 offset:48384
    s_waitcnt lgkmcnt(8)
    v_mfma_f32_32x32x16_bf16 v[64:79], v[24:27], a[52:55], v[64:79]
    ds_read_b64_tr_b16 v[16:17], v7 offset:49152
    ds_read_b64_tr_b16 v[18:19], v7 offset:49408
    v_mfma_f32_32x32x16_bf16 v[80:95], v[28:31], a[52:55], v[80:95]
    ds_read_b64_tr_b16 v[20:21], v7 offset:57344
    ds_read_b64_tr_b16 v[22:23], v7 offset:57600
    s_waitcnt lgkmcnt(8)
    v_mfma_f32_32x32x16_bf16 v[64:79], v[32:35], a[56:59], v[64:79]
    ds_read_b64_tr_b16 v[24:25], v7 offset:50176
    ds_read_b64_tr_b16 v[26:27], v7 offset:50432
    v_mfma_f32_32x32x16_bf16 v[80:95], v[36:39], a[56:59], v[80:95]
    ds_read_b64_tr_b16 v[28:29], v7 offset:58368
    ds_read_b64_tr_b16 v[30:31], v7 offset:58624
    s_waitcnt lgkmcnt(8)
    v_mfma_f32_32x32x16_bf16 v[64:79], v[40:43], a[60:63], v[64:79]
    ds_read_b64_tr_b16 v[32:33], v7 offset:51200
    ds_read_b64_tr_b16 v[34:35], v7 offset:51456
    v_mfma_f32_32x32x16_bf16 v[80:95], v[44:47], a[60:63], v[80:95]
    ds_read_b64_tr_b16 v[36:37], v7 offset:59392
    ds_read_b64_tr_b16 v[38:39], v7 offset:59648
    s_waitcnt lgkmcnt(8)
    v_mfma_f32_32x32x16_bf16 v[64:79], v[16:19], a[64:67], v[64:79]
    ds_read_b64_tr_b16 v[40:41], v7 offset:52224
    ds_read_b64_tr_b16 v[42:43], v7 offset:52480
    v_mfma_f32_32x32x16_bf16 v[80:95], v[20:23], a[64:67], v[80:95]
    ds_read_b64_tr_b16 v[44:45], v7 offset:60416
    ds_read_b64_tr_b16 v[46:47], v7 offset:60672
    s_waitcnt lgkmcnt(8)
    v_mfma_f32_32x32x16_bf16 v[64:79], v[24:27], a[68:71], v[64:79]
    s_bfe_u32 s6, s5, 524288
    s_add_u32 s6, s6, s76
    s_lshl_b32 s6, s6, 14
    s_add_u32 s78, s6, s77
    s_add_u32 s79, s78, 4096
    buffer_load_dwordx4 a[0:3], v2, s[12:15], s78 offen offset:0 sc1
    ds_read_b64_tr_b16 v[16:17], v7 offset:53248
    ds_read_b64_tr_b16 v[18:19], v7 offset:53504
    v_mfma_f32_32x32x16_bf16 v[80:95], v[28:31], a[68:71], v[80:95]
    buffer_load_dwordx4 a[4:7], v2, s[12:15], s78 offen offset:1024 sc1
    ds_read_b64_tr_b16 v[20:21], v7 offset:61440
    ds_read_b64_tr_b16 v[22:23], v7 offset:61696
    s_waitcnt lgkmcnt(8)
    v_mfma_f32_32x32x16_bf16 v[64:79], v[32:35], a[72:75], v[64:79]
    buffer_load_dwordx4 a[8:11], v2, s[12:15], s78 offen offset:2048 sc1
    ds_read_b64_tr_b16 v[24:25], v7 offset:54272
    ds_read_b64_tr_b16 v[26:27], v7 offset:54528
    v_mfma_f32_32x32x16_bf16 v[80:95], v[36:39], a[72:75], v[80:95]
    buffer_load_dwordx4 a[12:15], v2, s[12:15], s78 offen offset:3072 sc1
    ds_read_b64_tr_b16 v[28:29], v7 offset:62464
    ds_read_b64_tr_b16 v[30:31], v7 offset:62720
    s_waitcnt lgkmcnt(8)
    v_mfma_f32_32x32x16_bf16 v[64:79], v[40:43], a[76:79], v[64:79]
    ds_read_b64_tr_b16 v[32:33], v7 offset:55296
    ds_read_b64_tr_b16 v[34:35], v7 offset:55552
    v_mfma_f32_32x32x16_bf16 v[80:95], v[44:47], a[76:79], v[80:95]
    buffer_load_dwordx4 a[16:19], v2, s[12:15], s79 offen offset:0 sc1
    ds_read_b64_tr_b16 v[36:37], v7 offset:63488
    ds_read_b64_tr_b16 v[38:39], v7 offset:63744
    s_waitcnt lgkmcnt(8)
    v_mfma_f32_32x32x16_bf16 v[64:79], v[16:19], a[80:83], v[64:79]
    buffer_load_dwordx4 a[20:23], v2, s[12:15], s79 offen offset:1024 sc1
    ds_read_b64_tr_b16 v[40:41], v7 offset:56320
    ds_read_b64_tr_b16 v[42:43], v7 offset:56576
    v_mfma_f32_32x32x16_bf16 v[80:95], v[20:23], a[80:83], v[80:95]
    s_barrier
    buffer_load_dwordx4 a[24:27], v2, s[12:15], s79 offen offset:2048 sc1
    ds_read_b64_tr_b16 v[44:45], v7 offset:64512
    ds_read_b64_tr_b16 v[46:47], v7 offset:64768
    s_waitcnt lgkmcnt(8)
    v_mfma_f32_32x32x16_bf16 v[64:79], v[24:27], a[84:87], v[64:79]
    buffer_load_dwordx4 a[28:31], v2, s[12:15], s79 offen offset:3072 sc1
    ds_read_b64_tr_b16 v[16:17], v8 offset:0
    ds_read_b64_tr_b16 v[18:19], v8 offset:256
    v_mfma_f32_32x32x16_bf16 v[80:95], v[28:31], a[84:87], v[80:95]
    ds_read_b64_tr_b16 v[20:21], v8 offset:8192
    ds_read_b64_tr_b16 v[22:23], v8 offset:8448
    s_waitcnt lgkmcnt(8)
    v_mfma_f32_32x32x16_bf16 v[64:79], v[32:35], a[88:91], v[64:79]
    ds_read_b64_tr_b16 v[24:25], v8 offset:1024
    ds_read_b64_tr_b16 v[26:27], v8 offset:1280
    v_mfma_f32_32x32x16_bf16 v[80:95], v[36:39], a[88:91], v[80:95]
    ds_read_b64_tr_b16 v[28:29], v8 offset:9216
    ds_read_b64_tr_b16 v[30:31], v8 offset:9472
    s_waitcnt lgkmcnt(8)
    v_mfma_f32_32x32x16_bf16 v[64:79], v[40:43], a[92:95], v[64:79]
    ds_read_b64_tr_b16 v[32:33], v8 offset:2048
    ds_read_b64_tr_b16 v[34:35], v8 offset:2304
    v_mfma_f32_32x32x16_bf16 v[80:95], v[44:47], a[92:95], v[80:95]
    s_bfe_u32 s6, s5, 524296
    s_add_u32 s6, s6, s76
    s_lshl_b32 s6, s6, 14
    s_add_u32 s78, s6, s77
    s_add_u32 s79, s78, 4096
    buffer_load_dwordx4 a[32:35], v2, s[12:15], s78 offen offset:0 sc1
    ds_read_b64_tr_b16 v[36:37], v8 offset:10240
    ds_read_b64_tr_b16 v[38:39], v8 offset:10496
    s_waitcnt lgkmcnt(8)
    v_mfma_f32_32x32x16_bf16 v[64:79], v[16:19], a[96:99], v[64:79]
    buffer_load_dwordx4 a[36:39], v2, s[12:15], s78 offen offset:1024 sc1
    ds_read_b64_tr_b16 v[40:41], v8 offset:3072
    ds_read_b64_tr_b16 v[42:43], v8 offset:3328
    v_mfma_f32_32x32x16_bf16 v[80:95], v[20:23], a[96:99], v[80:95]
    buffer_load_dwordx4 a[40:43], v2, s[12:15], s78 offen offset:2048 sc1
    ds_read_b64_tr_b16 v[44:45], v8 offset:11264
    ds_read_b64_tr_b16 v[46:47], v8 offset:11520
    s_waitcnt lgkmcnt(8)
    v_mfma_f32_32x32x16_bf16 v[64:79], v[24:27], a[100:103], v[64:79]
    buffer_load_dwordx4 a[44:47], v2, s[12:15], s78 offen offset:3072 sc1
    ds_read_b64_tr_b16 v[16:17], v8 offset:4096
    ds_read_b64_tr_b16 v[18:19], v8 offset:4352
    v_mfma_f32_32x32x16_bf16 v[80:95], v[28:31], a[100:103], v[80:95]
    ds_read_b64_tr_b16 v[20:21], v8 offset:12288
    ds_read_b64_tr_b16 v[22:23], v8 offset:12544
    s_waitcnt lgkmcnt(8)
    v_mfma_f32_32x32x16_bf16 v[64:79], v[32:35], a[104:107], v[64:79]
    buffer_load_dwordx4 a[48:51], v2, s[12:15], s79 offen offset:0 sc1
    ds_read_b64_tr_b16 v[24:25], v8 offset:5120
    ds_read_b64_tr_b16 v[26:27], v8 offset:5376
    v_mfma_f32_32x32x16_bf16 v[80:95], v[36:39], a[104:107], v[80:95]
    buffer_load_dwordx4 a[52:55], v2, s[12:15], s79 offen offset:1024 sc1
    ds_read_b64_tr_b16 v[28:29], v8 offset:13312
    ds_read_b64_tr_b16 v[30:31], v8 offset:13568
    s_waitcnt lgkmcnt(8)
    v_mfma_f32_32x32x16_bf16 v[64:79], v[40:43], a[108:111], v[64:79]
    buffer_load_dwordx4 a[56:59], v2, s[12:15], s79 offen offset:2048 sc1
    ds_read_b64_tr_b16 v[32:33], v8 offset:6144
    ds_read_b64_tr_b16 v[34:35], v8 offset:6400
    v_mfma_f32_32x32x16_bf16 v[80:95], v[44:47], a[108:111], v[80:95]
    buffer_load_dwordx4 a[60:63], v2, s[12:15], s79 offen offset:3072 sc1
    ds_read_b64_tr_b16 v[36:37], v8 offset:14336
    ds_read_b64_tr_b16 v[38:39], v8 offset:14592
    s_waitcnt lgkmcnt(8)
    v_mfma_f32_32x32x16_bf16 v[64:79], v[16:19], a[112:115], v[64:79]
    ds_read_b64_tr_b16 v[40:41], v8 offset:7168
    ds_read_b64_tr_b16 v[42:43], v8 offset:7424
    v_mfma_f32_32x32x16_bf16 v[80:95], v[20:23], a[112:115], v[80:95]
    s_barrier
    ds_read_b64_tr_b16 v[44:45], v8 offset:15360
    ds_read_b64_tr_b16 v[46:47], v8 offset:15616
    s_waitcnt lgkmcnt(8)
    v_mfma_f32_32x32x16_bf16 v[64:79], v[24:27], a[116:119], v[64:79]
    v_mfma_f32_32x32x16_bf16 v[80:95], v[28:31], a[116:119], v[80:95]
    s_waitcnt lgkmcnt(4)
    v_mfma_f32_32x32x16_bf16 v[64:79], v[32:35], a[120:123], v[64:79]
    v_mfma_f32_32x32x16_bf16 v[80:95], v[36:39], a[120:123], v[80:95]
    s_waitcnt lgkmcnt(0)
    v_mfma_f32_32x32x16_bf16 v[64:79], v[40:43], a[124:127], v[64:79]
    v_mfma_f32_32x32x16_bf16 v[80:95], v[44:47], a[124:127], v[80:95]
    s_barrier
    v_lshrrev_b32 v56, 5, v1
    v_bfe_u32 v57, v1, 2, 2
    v_and_b32 v58, 3, v1
    v_bfe_u32 v59, v1, 4, 1
    v_lshlrev_b32 v60, 5, v59
    v_lshl_add_u32 v60, v58, 3, v60
    v_lshrrev_b32 v58, 1, v57
    v_lshlrev_b32 v58, 6, v58
    v_lshl_add_u32 v56, v56, 2, v57
    v_lshlrev_b32 v56, 7, v56
    v_add_u32 v56, s57, v56
    v_xor_b32 v57, v60, v58
    v_add_u32 v9, v56, v57
    v_or_b32 v60, 64, v60
    v_xor_b32 v57, v60, v58
    v_add_u32 v10, v56, v57
    v_add_u32 v11, 0x10000, v9
    v_add_u32 v12, 0x10000, v10
    s_cmp_eq_u32 s50, 0
    s_cbranch_scc0 Lo_29
    ds_read_b32 v16, v48 offset:1024
    ds_read_b32 v17, v48 offset:1024
    v_mov_b32 v18, 0
    v_mov_b32 v19, 0
    ds_read_b32 v20, v48 offset:1152
    ds_read_b32 v21, v48 offset:1152
    v_mov_b32 v22, 0
    v_mov_b32 v23, 0
    s_waitcnt lgkmcnt(2)
    v_mfma_f32_32x32x16_bf16 v[64:79], v[16:19], v[52:55], v[64:79]
    s_waitcnt lgkmcnt(0)
    v_mfma_f32_32x32x16_bf16 v[80:95], v[20:23], v[52:55], v[80:95]
    s_lshr_b32 s6, s49, 1
    s_add_u32 s6, s6, 24
    s_mul_i32 s7, s47, 36
    s_add_u32 s7, s7, s6
    s_lshl_b32 s7, s7, 2
    s_add_u32 s7, s7, s46
    s_lshl_b32 s7, s7, 12
    s_add_u32 s70, s7, 1048576
    s_and_b32 s6, s49, 1
    s_lshl_b32 s6, s6, 11
    s_add_u32 s70, s70, s6
    v_max_f32 v64, 0, v64
    v_max_f32 v65, 0, v65
    v_max_f32 v66, 0, v66
    v_max_f32 v67, 0, v67
    v_max_f32 v68, 0, v68
    v_max_f32 v69, 0, v69
    v_max_f32 v70, 0, v70
    v_max_f32 v71, 0, v71
    v_max_f32 v72, 0, v72
    v_max_f32 v73, 0, v73
    v_max_f32 v74, 0, v74
    v_max_f32 v75, 0, v75
    v_max_f32 v76, 0, v76
    v_max_f32 v77, 0, v77
    v_max_f32 v78, 0, v78
    v_max_f32 v79, 0, v79
    v_pk_mul_f32 v[64:65], v[64:65], v[80:81]
    v_pk_mul_f32 v[66:67], v[66:67], v[82:83]
    v_pk_mul_f32 v[68:69], v[68:69], v[84:85]
    v_pk_mul_f32 v[70:71], v[70:71], v[86:87]
    v_pk_mul_f32 v[72:73], v[72:73], v[88:89]
    v_pk_mul_f32 v[74:75], v[74:75], v[90:91]
    v_pk_mul_f32 v[76:77], v[76:77], v[92:93]
    v_pk_mul_f32 v[78:79], v[78:79], v[94:95]
    v_cvt_pk_bf16_f32 v32, v64, v65
    v_cvt_pk_bf16_f32 v33, v66, v67
    v_cvt_pk_bf16_f32 v34, v68, v69
    v_cvt_pk_bf16_f32 v35, v70, v71
    v_cvt_pk_bf16_f32 v36, v72, v73
    v_cvt_pk_bf16_f32 v37, v74, v75
    v_cvt_pk_bf16_f32 v38, v76, v77
    v_cvt_pk_bf16_f32 v39, v78, v79
    buffer_store_dwordx4 v[32:35], v2, s[12:15], s70 offen offset:0 sc1
    buffer_store_dwordx4 v[36:39], v2, s[12:15], s70 offen offset:1024 sc1
    s_branch Lj_30
Lo_29:
    ds_read_b32 v16, v48 offset:1024
    ds_read_b32 v17, v48 offset:1024
    v_mov_b32 v18, 0
    v_mov_b32 v19, 0
    ds_read_b32 v20, v48 offset:1152
    ds_read_b32 v21, v48 offset:1152
    v_mov_b32 v22, 0
    v_mov_b32 v23, 0
    s_waitcnt lgkmcnt(2)
    v_mfma_f32_32x32x16_bf16 v[64:79], v[16:19], v[52:55], v[64:79]
    s_waitcnt lgkmcnt(0)
    v_mfma_f32_32x32x16_bf16 v[80:95], v[20:23], v[52:55], v[80:95]
    s_add_u32 s6, s49, 28
    s_mul_i32 s7, s47, 36
    s_add_u32 s7, s7, s6
    s_lshl_b32 s7, s7, 2
    s_add_u32 s7, s7, s46
    s_lshl_b32 s7, s7, 12
    s_add_u32 s70, s7, 1048576
    v_add_u32 v44, 152576, v2
    ds_read_b128 v[16:19], v44 offset:0
    ds_read_b128 v[20:23], v44 offset:1024
    ds_read_b128 v[24:27], v44 offset:2048
    ds_read_b128 v[28:31], v44 offset:3072
    v_mul_f32 v56, v14, v64
    v_mul_f32 v57, v14, v65
    v_mul_f32 v58, v14, v66
    v_mul_f32 v59, v14, v67
    v_mul_f32 v60, v14, v68
    v_mul_f32 v61, v14, v69
    v_mul_f32 v62, v14, v70
    v_mul_f32 v63, v14, v71
    v_exp_f32 v56, v56 clamp
    v_exp_f32 v57, v57 clamp
    v_exp_f32 v58, v58 clamp
    v_exp_f32 v59, v59 clamp
    v_exp_f32 v60, v60 clamp
    v_exp_f32 v61, v61 clamp
    v_exp_f32 v62, v62 clamp
    v_exp_f32 v63, v63 clamp
    v_fma_f32 v64, v64, v13, s72
    v_fma_f32 v65, v65, v13, s72
    v_fma_f32 v66, v66, v13, s72
    v_fma_f32 v67, v67, v13, s72
    v_fma_f32 v68, v68, v13, s72
    v_fma_f32 v69, v69, v13, s72
    v_fma_f32 v70, v70, v13, s72
    v_fma_f32 v71, v71, v13, s72
    v_max_f32 v64, s72, v64
    v_max_f32 v65, s72, v65
    v_max_f32 v66, s72, v66
    v_max_f32 v67, s72, v67
    v_max_f32 v68, s72, v68
    v_max_f32 v69, s72, v69
    v_max_f32 v70, s72, v70
    v_max_f32 v71, s72, v71
    v_pk_add_f32 v[64:65], v[64:65], v[56:57]
    v_pk_add_f32 v[66:67], v[66:67], v[58:59]
    v_pk_add_f32 v[68:69], v[68:69], v[60:61]
    v_pk_add_f32 v[70:71], v[70:71], v[62:63]
    v_mul_f32 v56, v14, v72
    v_mul_f32 v57, v14, v73
    v_mul_f32 v58, v14, v74
    v_mul_f32 v59, v14, v75
    v_mul_f32 v60, v14, v76
    v_mul_f32 v61, v14, v77
    v_mul_f32 v62, v14, v78
    v_mul_f32 v63, v14, v79
    v_exp_f32 v56, v56 clamp
    v_exp_f32 v57, v57 clamp
    v_exp_f32 v58, v58 clamp
    v_exp_f32 v59, v59 clamp
    v_exp_f32 v60, v60 clamp
    v_exp_f32 v61, v61 clamp
    v_exp_f32 v62, v62 clamp
    v_exp_f32 v63, v63 clamp
    v_fma_f32 v72, v72, v13, s72
    v_fma_f32 v73, v73, v13, s72
    v_fma_f32 v74, v74, v13, s72
    v_fma_f32 v75, v75, v13, s72
    v_fma_f32 v76, v76, v13, s72
    v_fma_f32 v77, v77, v13, s72
    v_fma_f32 v78, v78, v13, s72
    v_fma_f32 v79, v79, v13, s72
    v_max_f32 v72, s72, v72
    v_max_f32 v73, s72, v73
    v_max_f32 v74, s72, v74
    v_max_f32 v75, s72, v75
    v_max_f32 v76, s72, v76
    v_max_f32 v77, s72, v77
    v_max_f32 v78, s72, v78
    v_max_f32 v79, s72, v79
    v_pk_add_f32 v[72:73], v[72:73], v[56:57]
    v_pk_add_f32 v[74:75], v[74:75], v[58:59]
    v_pk_add_f32 v[76:77], v[76:77], v[60:61]
    v_pk_add_f32 v[78:79], v[78:79], v[62:63]
    v_cvt_pk_bf16_f32 v32, v64, v65
    v_cvt_pk_bf16_f32 v33, v66, v67
    v_cvt_pk_bf16_f32 v34, v68, v69
    v_cvt_pk_bf16_f32 v35, v70, v71
    v_cvt_pk_bf16_f32 v36, v72, v73
    v_cvt_pk_bf16_f32 v37, v74, v75
    v_cvt_pk_bf16_f32 v38, v76, v77
    v_cvt_pk_bf16_f32 v39, v78, v79
    v_mul_f32 v56, v14, v80
    v_mul_f32 v57, v14, v81
    v_mul_f32 v58, v14, v82
    v_mul_f32 v59, v14, v83
    v_mul_f32 v60, v14, v84
    v_mul_f32 v61, v14, v85
    v_mul_f32 v62, v14, v86
    v_mul_f32 v63, v14, v87
    v_exp_f32 v56, v56 clamp
    v_exp_f32 v57, v57 clamp
    v_exp_f32 v58, v58 clamp
    v_exp_f32 v59, v59 clamp
    v_exp_f32 v60, v60 clamp
    v_exp_f32 v61, v61 clamp
    v_exp_f32 v62, v62 clamp
    v_exp_f32 v63, v63 clamp
    v_fma_f32 v80, v80, v13, s72
    v_fma_f32 v81, v81, v13, s72
    v_fma_f32 v82, v82, v13, s72
    v_fma_f32 v83, v83, v13, s72
    v_fma_f32 v84, v84, v13, s72
    v_fma_f32 v85, v85, v13, s72
    v_fma_f32 v86, v86, v13, s72
    v_fma_f32 v87, v87, v13, s72
    v_max_f32 v80, s72, v80
    v_max_f32 v81, s72, v81
    v_max_f32 v82, s72, v82
    v_max_f32 v83, s72, v83
    v_max_f32 v84, s72, v84
    v_max_f32 v85, s72, v85
    v_max_f32 v86, s72, v86
    v_max_f32 v87, s72, v87
    v_pk_add_f32 v[80:81], v[80:81], v[56:57]
    v_pk_add_f32 v[82:83], v[82:83], v[58:59]
    v_pk_add_f32 v[84:85], v[84:85], v[60:61]
    v_pk_add_f32 v[86:87], v[86:87], v[62:63]
    v_mul_f32 v56, v14, v88
    v_mul_f32 v57, v14, v89
    v_mul_f32 v58, v14, v90
    v_mul_f32 v59, v14, v91
    v_mul_f32 v60, v14, v92
    v_mul_f32 v61, v14, v93
    v_mul_f32 v62, v14, v94
    v_mul_f32 v63, v14, v95
    v_exp_f32 v56, v56 clamp
    v_exp_f32 v57, v57 clamp
    v_exp_f32 v58, v58 clamp
    v_exp_f32 v59, v59 clamp
    v_exp_f32 v60, v60 clamp
    v_exp_f32 v61, v61 clamp
    v_exp_f32 v62, v62 clamp
    v_exp_f32 v63, v63 clamp
    v_fma_f32 v88, v88, v13, s72
    v_fma_f32 v89, v89, v13, s72
    v_fma_f32 v90, v90, v13, s72
    v_fma_f32 v91, v91, v13, s72
    v_fma_f32 v92, v92, v13, s72
    v_fma_f32 v93, v93, v13, s72
    v_fma_f32 v94, v94, v13, s72
    v_fma_f32 v95, v95, v13, s72
    v_max_f32 v88, s72, v88
    v_max_f32 v89, s72, v89
    v_max_f32 v90, s72, v90
    v_max_f32 v91, s72, v91
    v_max_f32 v92, s72, v92
    v_max_f32 v93, s72, v93
    v_max_f32 v94, s72, v94
    v_max_f32 v95, s72, v95
    v_pk_add_f32 v[88:89], v[88:89], v[56:57]
    v_pk_add_f32 v[90:91], v[90:91], v[58:59]
    v_pk_add_f32 v[92:93], v[92:93], v[60:61]
    v_pk_add_f32 v[94:95], v[94:95], v[62:63]
    v_cvt_pk_bf16_f32 v56, v80, v81
    v_cvt_pk_bf16_f32 v57, v82, v83
    v_cvt_pk_bf16_f32 v58, v84, v85
    v_cvt_pk_bf16_f32 v59, v86, v87
    v_cvt_pk_bf16_f32 v60, v88, v89
    v_cvt_pk_bf16_f32 v61, v90, v91
    v_cvt_pk_bf16_f32 v62, v92, v93
    v_cvt_pk_bf16_f32 v63, v94, v95
    v_mul_f32 v45, v13, v13
    s_waitcnt lgkmcnt(0)
    v_mfma_f32_32x32x16_bf16 v[64:79], v[16:19], v[32:35], 0
    v_mfma_f32_32x32x16_bf16 v[80:95], v[20:23], v[36:39], 0
    v_mfma_f32_32x32x16_bf16 v[96:111], v[24:27], v[56:59], 0
    v_mfma_f32_32x32x16_bf16 v[112:127], v[28:31], v[60:63], 0
    s_nop 8
    v_add_f32 v72, s72, v72
    v_mul_f32 v72, v72, v45
    v_rcp_f32 v72, v72
    s_nop 0
    v_mov_b32 v73, v72
    v_pk_mul_f32 v[64:65], v[64:65], v[72:73]
    v_pk_mul_f32 v[66:67], v[66:67], v[72:73]
    v_pk_mul_f32 v[68:69], v[68:69], v[72:73]
    v_pk_mul_f32 v[70:71], v[70:71], v[72:73]
    v_cvt_pk_bf16_f32 v16, v64, v65
    v_cvt_pk_bf16_f32 v17, v66, v67
    v_cvt_pk_bf16_f32 v18, v68, v69
    v_cvt_pk_bf16_f32 v19, v70, v71
    buffer_store_dwordx4 v[16:19], v2, s[12:15], s70 offen offset:0 sc1
    v_add_f32 v88, s72, v88
    v_mul_f32 v88, v88, v45
    v_rcp_f32 v88, v88
    s_nop 0
    v_mov_b32 v89, v88
    v_pk_mul_f32 v[80:81], v[80:81], v[88:89]
    v_pk_mul_f32 v[82:83], v[82:83], v[88:89]
    v_pk_mul_f32 v[84:85], v[84:85], v[88:89]
    v_pk_mul_f32 v[86:87], v[86:87], v[88:89]
    v_cvt_pk_bf16_f32 v20, v80, v81
    v_cvt_pk_bf16_f32 v21, v82, v83
    v_cvt_pk_bf16_f32 v22, v84, v85
    v_cvt_pk_bf16_f32 v23, v86, v87
    buffer_store_dwordx4 v[20:23], v2, s[12:15], s70 offen offset:1024 sc1
    v_add_f32 v104, s72, v104
    v_mul_f32 v104, v104, v45
    v_rcp_f32 v104, v104
    s_nop 0
    v_mov_b32 v105, v104
    v_pk_mul_f32 v[96:97], v[96:97], v[104:105]
    v_pk_mul_f32 v[98:99], v[98:99], v[104:105]
    v_pk_mul_f32 v[100:101], v[100:101], v[104:105]
    v_pk_mul_f32 v[102:103], v[102:103], v[104:105]
    v_cvt_pk_bf16_f32 v24, v96, v97
    v_cvt_pk_bf16_f32 v25, v98, v99
    v_cvt_pk_bf16_f32 v26, v100, v101
    v_cvt_pk_bf16_f32 v27, v102, v103
    buffer_store_dwordx4 v[24:27], v2, s[12:15], s70 offen offset:2048 sc1
    v_add_f32 v120, s72, v120
    v_mul_f32 v120, v120, v45
    v_rcp_f32 v120, v120
    s_nop 0
    v_mov_b32 v121, v120
    v_pk_mul_f32 v[112:113], v[112:113], v[120:121]
    v_pk_mul_f32 v[114:115], v[114:115], v[120:121]
    v_pk_mul_f32 v[116:117], v[116:117], v[120:121]
    v_pk_mul_f32 v[118:119], v[118:119], v[120:121]
    v_cvt_pk_bf16_f32 v28, v112, v113
    v_cvt_pk_bf16_f32 v29, v114, v115
    v_cvt_pk_bf16_f32 v30, v116, v117
    v_cvt_pk_bf16_f32 v31, v118, v119
    buffer_store_dwordx4 v[28:31], v2, s[12:15], s70 offen offset:3072 sc1
Lj_30:
    s_barrier
    ds_read_b64_tr_b16 v[16:17], v11 offset:16384
    ds_read_b64_tr_b16 v[18:19], v11 offset:17408
    ds_read_b64_tr_b16 v[20:21], v12 offset:16384
    ds_read_b64_tr_b16 v[22:23], v12 offset:17408
    ds_read_b64_tr_b16 v[24:25], v11 offset:18432
    ds_read_b64_tr_b16 v[26:27], v11 offset:19456
    s_waitcnt lgkmcnt(4)
    s_waitcnt vmcnt(10)
    v_mfma_f32_32x32x16_bf16 v[64:79], v[16:19], a[0:3], 0
    ds_read_b64_tr_b16 v[28:29], v12 offset:18432
    ds_read_b64_tr_b16 v[30:31], v12 offset:19456
    v_mfma_f32_32x32x16_bf16 v[80:95], v[16:19], a[16:19], 0
    s_bfe_u32 s6, s5, 524304
    s_add_u32 s6, s6, s76
    s_lshl_b32 s6, s6, 14
    s_add_u32 s78, s6, s77
    s_add_u32 s79, s78, 4096
    buffer_load_dwordx4 a[64:67], v2, s[12:15], s78 offen offset:0 sc1
    s_waitcnt lgkmcnt(4)
    v_mfma_f32_32x32x16_bf16 v[96:111], v[20:23], a[0:3], 0
    buffer_load_dwordx4 a[68:71], v2, s[12:15], s78 offen offset:1024 sc1
    ds_read_b64_tr_b16 v[32:33], v11 offset:20480
    ds_read_b64_tr_b16 v[34:35], v11 offset:21504
    v_mfma_f32_32x32x16_bf16 v[112:127], v[20:23], a[16:19], 0
    buffer_load_dwordx4 a[72:75], v2, s[12:15], s78 offen offset:2048 sc1
    s_waitcnt lgkmcnt(4)
    v_mfma_f32_32x32x16_bf16 v[64:79], v[24:27], a[4:7], v[64:79]
    buffer_load_dwordx4 a[76:79], v2, s[12:15], s78 offen offset:3072 sc1
    ds_read_b64_tr_b16 v[36:37], v12 offset:20480
    ds_read_b64_tr_b16 v[38:39], v12 offset:21504
    v_mfma_f32_32x32x16_bf16 v[80:95], v[24:27], a[20:23], v[80:95]
    buffer_load_dwordx4 a[80:83], v2, s[12:15], s79 offen offset:0 sc1
    s_waitcnt lgkmcnt(4)
    v_mfma_f32_32x32x16_bf16 v[96:111], v[28:31], a[4:7], v[96:111]
    buffer_load_dwordx4 a[84:87], v2, s[12:15], s79 offen offset:1024 sc1
    ds_read_b64_tr_b16 v[40:41], v11 offset:22528
    ds_read_b64_tr_b16 v[42:43], v11 offset:23552
    v_mfma_f32_32x32x16_bf16 v[112:127], v[28:31], a[20:23], v[112:127]
    buffer_load_dwordx4 a[88:91], v2, s[12:15], s79 offen offset:2048 sc1
    s_waitcnt lgkmcnt(4)
    v_mfma_f32_32x32x16_bf16 v[64:79], v[32:35], a[8:11], v[64:79]
    buffer_load_dwordx4 a[92:95], v2, s[12:15], s79 offen offset:3072 sc1
    ds_read_b64_tr_b16 v[44:45], v12 offset:22528
    ds_read_b64_tr_b16 v[46:47], v12 offset:23552
    v_mfma_f32_32x32x16_bf16 v[80:95], v[32:35], a[24:27], v[80:95]
    s_waitcnt vmcnt(8)
    s_barrier
    s_waitcnt lgkmcnt(4)
    v_mfma_f32_32x32x16_bf16 v[96:111], v[36:39], a[8:11], v[96:111]
    ds_read_b64_tr_b16 v[16:17], v9 offset:0
    ds_read_b64_tr_b16 v[18:19], v9 offset:1024
    v_mfma_f32_32x32x16_bf16 v[112:127], v[36:39], a[24:27], v[112:127]
    s_waitcnt lgkmcnt(4)
    v_mfma_f32_32x32x16_bf16 v[64:79], v[40:43], a[12:15], v[64:79]
    ds_read_b64_tr_b16 v[20:21], v10 offset:0
    ds_read_b64_tr_b16 v[22:23], v10 offset:1024
    v_mfma_f32_32x32x16_bf16 v[80:95], v[40:43], a[28:31], v[80:95]
    s_waitcnt lgkmcnt(4)
    v_mfma_f32_32x32x16_bf16 v[96:111], v[44:47], a[12:15], v[96:111]
    ds_read_b64_tr_b16 v[24:25], v9 offset:2048
    ds_read_b64_tr_b16 v[26:27], v9 offset:3072
    v_mfma_f32_32x32x16_bf16 v[112:127], v[44:47], a[28:31], v[112:127]
    s_waitcnt lgkmcnt(4)
    s_waitcnt vmcnt(10)
    v_mfma_f32_32x32x16_bf16 v[64:79], v[16:19], a[32:35], v[64:79]
    ds_read_b64_tr_b16 v[28:29], v10 offset:2048
    ds_read_b64_tr_b16 v[30:31], v10 offset:3072
    v_mfma_f32_32x32x16_bf16 v[80:95], v[16:19], a[48:51], v[80:95]
    s_bfe_u32 s6, s5, 524312
    s_add_u32 s6, s6, s76
    s_lshl_b32 s6, s6, 14
    s_add_u32 s78, s6, s77
    s_add_u32 s79, s78, 4096
    buffer_load_dwordx4 a[0:3], v2, s[12:15], s78 offen offset:0 sc1
    s_waitcnt lgkmcnt(4)
    v_mfma_f32_32x32x16_bf16 v[96:111], v[20:23], a[32:35], v[96:111]
    buffer_load_dwordx4 a[4:7], v2, s[12:15], s78 offen offset:1024 sc1
    ds_read_b64_tr_b16 v[32:33], v9 offset:4096
    ds_read_b64_tr_b16 v[34:35], v9 offset:5120
    v_mfma_f32_32x32x16_bf16 v[112:127], v[20:23], a[48:51], v[112:127]
    buffer_load_dwordx4 a[8:11], v2, s[12:15], s78 offen offset:2048 sc1
    s_waitcnt lgkmcnt(4)
    v_mfma_f32_32x32x16_bf16 v[64:79], v[24:27], a[36:39], v[64:79]
    buffer_load_dwordx4 a[12:15], v2, s[12:15], s78 offen offset:3072 sc1
    ds_read_b64_tr_b16 v[36:37], v10 offset:4096
    ds_read_b64_tr_b16 v[38:39], v10 offset:5120
    v_mfma_f32_32x32x16_bf16 v[80:95], v[24:27], a[52:55], v[80:95]
    buffer_load_dwordx4 a[16:19], v2, s[12:15], s79 offen offset:0 sc1
    s_waitcnt lgkmcnt(4)
    v_mfma_f32_32x32x16_bf16 v[96:111], v[28:31], a[36:39], v[96:111]
    buffer_load_dwordx4 a[20:23], v2, s[12:15], s79 offen offset:1024 sc1
    ds_read_b64_tr_b16 v[40:41], v9 offset:6144
    ds_read_b64_tr_b16 v[42:43], v9 offset:7168
    v_mfma_f32_32x32x16_bf16 v[112:127], v[28:31], a[52:55], v[112:127]
    buffer_load_dwordx4 a[24:27], v2, s[12:15], s79 offen offset:2048 sc1
    s_waitcnt lgkmcnt(4)
    v_mfma_f32_32x32x16_bf16 v[64:79], v[32:35], a[40:43], v[64:79]
    buffer_load_dwordx4 a[28:31], v2, s[12:15], s79 offen offset:3072 sc1
    ds_read_b64_tr_b16 v[44:45], v10 offset:6144
    ds_read_b64_tr_b16 v[46:47], v10 offset:7168
    v_mfma_f32_32x32x16_bf16 v[80:95], v[32:35], a[56:59], v[80:95]
    s_barrier
    s_waitcnt lgkmcnt(4)
    v_mfma_f32_32x32x16_bf16 v[96:111], v[36:39], a[40:43], v[96:111]
    ds_read_b64_tr_b16 v[16:17], v9 offset:32768
    ds_read_b64_tr_b16 v[18:19], v9 offset:33792
    v_mfma_f32_32x32x16_bf16 v[112:127], v[36:39], a[56:59], v[112:127]
    s_waitcnt lgkmcnt(4)
    v_mfma_f32_32x32x16_bf16 v[64:79], v[40:43], a[44:47], v[64:79]
    ds_read_b64_tr_b16 v[20:21], v10 offset:32768
    ds_read_b64_tr_b16 v[22:23], v10 offset:33792
    v_mfma_f32_32x32x16_bf16 v[80:95], v[40:43], a[60:63], v[80:95]
    s_waitcnt lgkmcnt(4)
    v_mfma_f32_32x32x16_bf16 v[96:111], v[44:47], a[44:47], v[96:111]
    ds_read_b64_tr_b16 v[24:25], v9 offset:34816
    ds_read_b64_tr_b16 v[26:27], v9 offset:35840
    v_mfma_f32_32x32x16_bf16 v[112:127], v[44:47], a[60:63], v[112:127]
    s_waitcnt lgkmcnt(4)
    s_waitcnt vmcnt(8)
    v_mfma_f32_32x32x16_bf16 v[64:79], v[16:19], a[64:67], v[64:79]
    ds_read_b64_tr_b16 v[28:29], v10 offset:34816
    ds_read_b64_tr_b16 v[30:31], v10 offset:35840
    v_mfma_f32_32x32x16_bf16 v[80:95], v[16:19], a[80:83], v[80:95]
    s_bfe_u32 s6, s3, 524288
    s_add_u32 s6, s6, s76
    s_lshl_b32 s6, s6, 14
    s_add_u32 s78, s6, s77
    s_add_u32 s79, s78, 4096
    buffer_load_dwordx4 a[32:35], v2, s[12:15], s78 offen offset:0 sc1
    s_waitcnt lgkmcnt(4)
    v_mfma_f32_32x32x16_bf16 v[96:111], v[20:23], a[64:67], v[96:111]
    buffer_load_dwordx4 a[36:39], v2, s[12:15], s78 offen offset:1024 sc1
    ds_read_b64_tr_b16 v[32:33], v9 offset:36864
    ds_read_b64_tr_b16 v[34:35], v9 offset:37888
    v_mfma_f32_32x32x16_bf16 v[112:127], v[20:23], a[80:83], v[112:127]
    buffer_load_dwordx4 a[40:43], v2, s[12:15], s78 offen offset:2048 sc1
    s_waitcnt lgkmcnt(4)
    v_mfma_f32_32x32x16_bf16 v[64:79], v[24:27], a[68:71], v[64:79]
    buffer_load_dwordx4 a[44:47], v2, s[12:15], s78 offen offset:3072 sc1
    ds_read_b64_tr_b16 v[36:37], v10 offset:36864
    ds_read_b64_tr_b16 v[38:39], v10 offset:37888
    v_mfma_f32_32x32x16_bf16 v[80:95], v[24:27], a[84:87], v[80:95]
    buffer_load_dwordx4 a[48:51], v2, s[12:15], s79 offen offset:0 sc1
    s_waitcnt lgkmcnt(4)
    v_mfma_f32_32x32x16_bf16 v[96:111], v[28:31], a[68:71], v[96:111]
    buffer_load_dwordx4 a[52:55], v2, s[12:15], s79 offen offset:1024 sc1
    ds_read_b64_tr_b16 v[40:41], v9 offset:38912
    ds_read_b64_tr_b16 v[42:43], v9 offset:39936
    v_mfma_f32_32x32x16_bf16 v[112:127], v[28:31], a[84:87], v[112:127]
    buffer_load_dwordx4 a[56:59], v2, s[12:15], s79 offen offset:2048 sc1
    s_waitcnt lgkmcnt(4)
    v_mfma_f32_32x32x16_bf16 v[64:79], v[32:35], a[72:75], v[64:79]
    buffer_load_dwordx4 a[60:63], v2, s[12:15], s79 offen offset:3072 sc1
    ds_read_b64_tr_b16 v[44:45], v10 offset:38912
    ds_read_b64_tr_b16 v[46:47], v10 offset:39936
    v_mfma_f32_32x32x16_bf16 v[80:95], v[32:35], a[88:91], v[80:95]
    s_barrier
    s_waitcnt lgkmcnt(4)
    v_mfma_f32_32x32x16_bf16 v[96:111], v[36:39], a[72:75], v[96:111]
    ds_read_b64_tr_b16 v[16:17], v11 offset:49152
    ds_read_b64_tr_b16 v[18:19], v11 offset:50176
    v_mfma_f32_32x32x16_bf16 v[112:127], v[36:39], a[88:91], v[112:127]
    s_waitcnt lgkmcnt(4)
    v_mfma_f32_32x32x16_bf16 v[64:79], v[40:43], a[76:79], v[64:79]
    ds_read_b64_tr_b16 v[20:21], v12 offset:49152
    ds_read_b64_tr_b16 v[22:23], v12 offset:50176
    v_mfma_f32_32x32x16_bf16 v[80:95], v[40:43], a[92:95], v[80:95]
    s_waitcnt lgkmcnt(4)
    v_mfma_f32_32x32x16_bf16 v[96:111], v[44:47], a[76:79], v[96:111]
    ds_read_b64_tr_b16 v[24:25], v11 offset:51200
    ds_read_b64_tr_b16 v[26:27], v11 offset:52224
    v_mfma_f32_32x32x16_bf16 v[112:127], v[44:47], a[92:95], v[112:127]
    s_waitcnt lgkmcnt(4)
    s_waitcnt vmcnt(8)
    v_mfma_f32_32x32x16_bf16 v[64:79], v[16:19], a[0:3], v[64:79]
    ds_read_b64_tr_b16 v[28:29], v12 offset:51200
    ds_read_b64_tr_b16 v[30:31], v12 offset:52224
    v_mfma_f32_32x32x16_bf16 v[80:95], v[16:19], a[16:19], v[80:95]
    s_bfe_u32 s6, s3, 524296
    s_add_u32 s6, s6, s76
    s_lshl_b32 s6, s6, 14
    s_add_u32 s78, s6, s77
    s_add_u32 s79, s78, 4096
    buffer_load_dwordx4 a[64:67], v2, s[12:15], s78 offen offset:0 sc1
    s_waitcnt lgkmcnt(4)
    v_mfma_f32_32x32x16_bf16 v[96:111], v[20:23], a[0:3], v[96:111]
    buffer_load_dwordx4 a[68:71], v2, s[12:15], s78 offen offset:1024 sc1
    ds_read_b64_tr_b16 v[32:33], v11 offset:53248
    ds_read_b64_tr_b16 v[34:35], v11 offset:54272
    v_mfma_f32_32x32x16_bf16 v[112:127], v[20:23], a[16:19], v[112:127]
    buffer_load_dwordx4 a[72:75], v2, s[12:15], s78 offen offset:2048 sc1
    s_waitcnt lgkmcnt(4)
    v_mfma_f32_32x32x16_bf16 v[64:79], v[24:27], a[4:7], v[64:79]
    buffer_load_dwordx4 a[76:79], v2, s[12:15], s78 offen offset:3072 sc1
    ds_read_b64_tr_b16 v[36:37], v12 offset:53248
    ds_read_b64_tr_b16 v[38:39], v12 offset:54272
    v_mfma_f32_32x32x16_bf16 v[80:95], v[24:27], a[20:23], v[80:95]
    buffer_load_dwordx4 a[80:83], v2, s[12:15], s79 offen offset:0 sc1
    s_waitcnt lgkmcnt(4)
    v_mfma_f32_32x32x16_bf16 v[96:111], v[28:31], a[4:7], v[96:111]
    buffer_load_dwordx4 a[84:87], v2, s[12:15], s79 offen offset:1024 sc1
    ds_read_b64_tr_b16 v[40:41], v11 offset:55296
    ds_read_b64_tr_b16 v[42:43], v11 offset:56320
    v_mfma_f32_32x32x16_bf16 v[112:127], v[28:31], a[20:23], v[112:127]
    buffer_load_dwordx4 a[88:91], v2, s[12:15], s79 offen offset:2048 sc1
    s_waitcnt lgkmcnt(4)
    v_mfma_f32_32x32x16_bf16 v[64:79], v[32:35], a[8:11], v[64:79]
    buffer_load_dwordx4 a[92:95], v2, s[12:15], s79 offen offset:3072 sc1
    ds_read_b64_tr_b16 v[44:45], v12 offset:55296
    ds_read_b64_tr_b16 v[46:47], v12 offset:56320
    v_mfma_f32_32x32x16_bf16 v[80:95], v[32:35], a[24:27], v[80:95]
    s_barrier
    s_waitcnt lgkmcnt(4)
    v_mfma_f32_32x32x16_bf16 v[96:111], v[36:39], a[8:11], v[96:111]
    ds_read_b64_tr_b16 v[16:17], v11 offset:16384
    ds_read_b64_tr_b16 v[18:19], v11 offset:17408
    v_mfma_f32_32x32x16_bf16 v[112:127], v[36:39], a[24:27], v[112:127]
    s_waitcnt lgkmcnt(4)
    v_mfma_f32_32x32x16_bf16 v[64:79], v[40:43], a[12:15], v[64:79]
    ds_read_b64_tr_b16 v[20:21], v12 offset:16384
    ds_read_b64_tr_b16 v[22:23], v12 offset:17408
    v_mfma_f32_32x32x16_bf16 v[80:95], v[40:43], a[28:31], v[80:95]
    s_waitcnt lgkmcnt(4)
    v_mfma_f32_32x32x16_bf16 v[96:111], v[44:47], a[12:15], v[96:111]
    ds_read_b64_tr_b16 v[24:25], v11 offset:18432
    ds_read_b64_tr_b16 v[26:27], v11 offset:19456
    v_mfma_f32_32x32x16_bf16 v[112:127], v[44:47], a[28:31], v[112:127]
    s_waitcnt lgkmcnt(4)
    s_waitcnt vmcnt(8)
    v_mfma_f32_32x32x16_bf16 v[64:79], v[16:19], a[32:35], v[64:79]
    ds_read_b64_tr_b16 v[28:29], v12 offset:18432
    ds_read_b64_tr_b16 v[30:31], v12 offset:19456
    v_mfma_f32_32x32x16_bf16 v[80:95], v[16:19], a[48:51], v[80:95]
    s_waitcnt lgkmcnt(4)
    v_mfma_f32_32x32x16_bf16 v[96:111], v[20:23], a[32:35], v[96:111]
    ds_read_b64_tr_b16 v[32:33], v11 offset:20480
    ds_read_b64_tr_b16 v[34:35], v11 offset:21504
    v_mfma_f32_32x32x16_bf16 v[112:127], v[20:23], a[48:51], v[112:127]
    s_waitcnt lgkmcnt(4)
    v_mfma_f32_32x32x16_bf16 v[64:79], v[24:27], a[36:39], v[64:79]
    ds_read_b64_tr_b16 v[36:37], v12 offset:20480
    ds_read_b64_tr_b16 v[38:39], v12 offset:21504
    v_mfma_f32_32x32x16_bf16 v[80:95], v[24:27], a[52:55], v[80:95]
    s_waitcnt lgkmcnt(4)
    v_mfma_f32_32x32x16_bf16 v[96:111], v[28:31], a[36:39], v[96:111]
    ds_read_b64_tr_b16 v[40:41], v11 offset:22528
    ds_read_b64_tr_b16 v[42:43], v11 offset:23552
    v_mfma_f32_32x32x16_bf16 v[112:127], v[28:31], a[52:55], v[112:127]
    s_waitcnt lgkmcnt(4)
    v_mfma_f32_32x32x16_bf16 v[64:79], v[32:35], a[40:43], v[64:79]
    ds_read_b64_tr_b16 v[44:45], v12 offset:22528
    ds_read_b64_tr_b16 v[46:47], v12 offset:23552
    v_mfma_f32_32x32x16_bf16 v[80:95], v[32:35], a[56:59], v[80:95]
    s_barrier
    s_waitcnt lgkmcnt(4)
    v_mfma_f32_32x32x16_bf16 v[96:111], v[36:39], a[40:43], v[96:111]
    ds_read_b64_tr_b16 v[16:17], v9 offset:0
    ds_read_b64_tr_b16 v[18:19], v9 offset:1024
    v_mfma_f32_32x32x16_bf16 v[112:127], v[36:39], a[56:59], v[112:127]
    s_waitcnt lgkmcnt(4)
    v_mfma_f32_32x32x16_bf16 v[64:79], v[40:43], a[44:47], v[64:79]
    ds_read_b64_tr_b16 v[20:21], v10 offset:0
    ds_read_b64_tr_b16 v[22:23], v10 offset:1024
    v_mfma_f32_32x32x16_bf16 v[80:95], v[40:43], a[60:63], v[80:95]
    s_waitcnt lgkmcnt(4)
    v_mfma_f32_32x32x16_bf16 v[96:111], v[44:47], a[44:47], v[96:111]
    ds_read_b64_tr_b16 v[24:25], v9 offset:2048
    ds_read_b64_tr_b16 v[26:27], v9 offset:3072
    v_mfma_f32_32x32x16_bf16 v[112:127], v[44:47], a[60:63], v[112:127]
    s_waitcnt lgkmcnt(4)
    s_waitcnt vmcnt(0)
    v_mfma_f32_32x32x16_bf16 v[64:79], v[16:19], a[64:67], v[64:79]
    s_bfe_u32 s6, s3, 524304
    s_add_u32 s6, s6, s76
    s_lshl_b32 s6, s6, 14
    s_add_u32 s78, s6, s77
    s_add_u32 s79, s78, 4096
    buffer_load_dwordx4 a[0:3], v2, s[12:15], s78 offen offset:0 sc1
    buffer_load_dwordx4 a[4:7], v2, s[12:15], s78 offen offset:1024 sc1
    ds_read_b64_tr_b16 v[28:29], v10 offset:2048
    ds_read_b64_tr_b16 v[30:31], v10 offset:3072
    v_mfma_f32_32x32x16_bf16 v[80:95], v[16:19], a[80:83], v[80:95]
    buffer_load_dwordx4 a[8:11], v2, s[12:15], s78 offen offset:2048 sc1
    s_waitcnt lgkmcnt(4)
    v_mfma_f32_32x32x16_bf16 v[96:111], v[20:23], a[64:67], v[96:111]
    buffer_load_dwordx4 a[12:15], v2, s[12:15], s78 offen offset:3072 sc1
    ds_read_b64_tr_b16 v[32:33], v9 offset:4096
    ds_read_b64_tr_b16 v[34:35], v9 offset:5120
    v_mfma_f32_32x32x16_bf16 v[112:127], v[20:23], a[80:83], v[112:127]
    buffer_load_dwordx4 a[16:19], v2, s[12:15], s79 offen offset:0 sc1
    s_waitcnt lgkmcnt(4)
    v_mfma_f32_32x32x16_bf16 v[64:79], v[24:27], a[68:71], v[64:79]
    buffer_load_dwordx4 a[20:23], v2, s[12:15], s79 offen offset:1024 sc1
    ds_read_b64_tr_b16 v[36:37], v10 offset:4096
    ds_read_b64_tr_b16 v[38:39], v10 offset:5120
    v_mfma_f32_32x32x16_bf16 v[80:95], v[24:27], a[84:87], v[80:95]
    buffer_load_dwordx4 a[24:27], v2, s[12:15], s79 offen offset:2048 sc1
    s_waitcnt lgkmcnt(4)
    v_mfma_f32_32x32x16_bf16 v[96:111], v[28:31], a[68:71], v[96:111]
    buffer_load_dwordx4 a[28:31], v2, s[12:15], s79 offen offset:3072 sc1
    ds_read_b64_tr_b16 v[40:41], v9 offset:6144
    ds_read_b64_tr_b16 v[42:43], v9 offset:7168
    v_mfma_f32_32x32x16_bf16 v[112:127], v[28:31], a[84:87], v[112:127]
    s_bfe_u32 s6, s3, 524312
    s_add_u32 s6, s6, s76
    s_lshl_b32 s6, s6, 14
    s_add_u32 s78, s6, s77
    s_add_u32 s79, s78, 4096
    buffer_load_dwordx4 a[32:35], v2, s[12:15], s78 offen offset:0 sc1
    s_waitcnt lgkmcnt(4)
    v_mfma_f32_32x32x16_bf16 v[64:79], v[32:35], a[72:75], v[64:79]
    buffer_load_dwordx4 a[36:39], v2, s[12:15], s78 offen offset:1024 sc1
    ds_read_b64_tr_b16 v[44:45], v10 offset:6144
    ds_read_b64_tr_b16 v[46:47], v10 offset:7168
    v_mfma_f32_32x32x16_bf16 v[80:95], v[32:35], a[88:91], v[80:95]
    buffer_load_dwordx4 a[40:43], v2, s[12:15], s78 offen offset:2048 sc1
    s_barrier
    s_waitcnt lgkmcnt(4)
    v_mfma_f32_32x32x16_bf16 v[96:111], v[36:39], a[72:75], v[96:111]
    buffer_load_dwordx4 a[44:47], v2, s[12:15], s78 offen offset:3072 sc1
    ds_read_b64_tr_b16 v[16:17], v9 offset:32768
    ds_read_b64_tr_b16 v[18:19], v9 offset:33792
    v_mfma_f32_32x32x16_bf16 v[112:127], v[36:39], a[88:91], v[112:127]
    buffer_load_dwordx4 a[48:51], v2, s[12:15], s79 offen offset:0 sc1
    s_waitcnt lgkmcnt(4)
    v_mfma_f32_32x32x16_bf16 v[64:79], v[40:43], a[76:79], v[64:79]
    buffer_load_dwordx4 a[52:55], v2, s[12:15], s79 offen offset:1024 sc1
    ds_read_b64_tr_b16 v[20:21], v10 offset:32768
    ds_read_b64_tr_b16 v[22:23], v10 offset:33792
    v_mfma_f32_32x32x16_bf16 v[80:95], v[40:43], a[92:95], v[80:95]
    buffer_load_dwordx4 a[56:59], v2, s[12:15], s79 offen offset:2048 sc1
    s_waitcnt lgkmcnt(4)
    v_mfma_f32_32x32x16_bf16 v[96:111], v[44:47], a[76:79], v[96:111]
    buffer_load_dwordx4 a[60:63], v2, s[12:15], s79 offen offset:3072 sc1
    ds_read_b64_tr_b16 v[24:25], v9 offset:34816
    ds_read_b64_tr_b16 v[26:27], v9 offset:35840
    v_mfma_f32_32x32x16_bf16 v[112:127], v[44:47], a[92:95], v[112:127]
    s_waitcnt lgkmcnt(4)
    s_waitcnt vmcnt(8)
    v_mfma_f32_32x32x16_bf16 v[64:79], v[16:19], a[0:3], v[64:79]
    ds_read_b64_tr_b16 v[28:29], v10 offset:34816
    ds_read_b64_tr_b16 v[30:31], v10 offset:35840
    v_mfma_f32_32x32x16_bf16 v[80:95], v[16:19], a[16:19], v[80:95]
    s_bfe_u32 s6, s63, 524288
    s_add_u32 s6, s6, s76
    s_lshl_b32 s6, s6, 14
    s_add_u32 s78, s6, s77
    s_add_u32 s79, s78, 4096
    buffer_load_dwordx4 a[64:67], v2, s[12:15], s78 offen offset:0 sc1
    s_waitcnt lgkmcnt(4)
    v_mfma_f32_32x32x16_bf16 v[96:111], v[20:23], a[0:3], v[96:111]
    buffer_load_dwordx4 a[68:71], v2, s[12:15], s78 offen offset:1024 sc1
    ds_read_b64_tr_b16 v[32:33], v9 offset:36864
    ds_read_b64_tr_b16 v[34:35], v9 offset:37888
    v_mfma_f32_32x32x16_bf16 v[112:127], v[20:23], a[16:19], v[112:127]
    buffer_load_dwordx4 a[72:75], v2, s[12:15], s78 offen offset:2048 sc1
    s_waitcnt lgkmcnt(4)
    v_mfma_f32_32x32x16_bf16 v[64:79], v[24:27], a[4:7], v[64:79]
    buffer_load_dwordx4 a[76:79], v2, s[12:15], s78 offen offset:3072 sc1
    ds_read_b64_tr_b16 v[36:37], v10 offset:36864
    ds_read_b64_tr_b16 v[38:39], v10 offset:37888
    v_mfma_f32_32x32x16_bf16 v[80:95], v[24:27], a[20:23], v[80:95]
    buffer_load_dwordx4 a[80:83], v2, s[12:15], s79 offen offset:0 sc1
    s_waitcnt lgkmcnt(4)
    v_mfma_f32_32x32x16_bf16 v[96:111], v[28:31], a[4:7], v[96:111]
    buffer_load_dwordx4 a[84:87], v2, s[12:15], s79 offen offset:1024 sc1
    ds_read_b64_tr_b16 v[40:41], v9 offset:38912
    ds_read_b64_tr_b16 v[42:43], v9 offset:39936
    v_mfma_f32_32x32x16_bf16 v[112:127], v[28:31], a[20:23], v[112:127]
    buffer_load_dwordx4 a[88:91], v2, s[12:15], s79 offen offset:2048 sc1
    s_waitcnt lgkmcnt(4)
    v_mfma_f32_32x32x16_bf16 v[64:79], v[32:35], a[8:11], v[64:79]
    buffer_load_dwordx4 a[92:95], v2, s[12:15], s79 offen offset:3072 sc1
    ds_read_b64_tr_b16 v[44:45], v10 offset:38912
    ds_read_b64_tr_b16 v[46:47], v10 offset:39936
    v_mfma_f32_32x32x16_bf16 v[80:95], v[32:35], a[24:27], v[80:95]
    s_barrier
    s_waitcnt lgkmcnt(4)
    v_mfma_f32_32x32x16_bf16 v[96:111], v[36:39], a[8:11], v[96:111]
    ds_read_b64_tr_b16 v[16:17], v11 offset:49152
    ds_read_b64_tr_b16 v[18:19], v11 offset:50176
    v_mfma_f32_32x32x16_bf16 v[112:127], v[36:39], a[24:27], v[112:127]
    s_waitcnt lgkmcnt(4)
    v_mfma_f32_32x32x16_bf16 v[64:79], v[40:43], a[12:15], v[64:79]
    ds_read_b64_tr_b16 v[20:21], v12 offset:49152
    ds_read_b64_tr_b16 v[22:23], v12 offset:50176
    v_mfma_f32_32x32x16_bf16 v[80:95], v[40:43], a[28:31], v[80:95]
    s_waitcnt lgkmcnt(4)
    v_mfma_f32_32x32x16_bf16 v[96:111], v[44:47], a[12:15], v[96:111]
    ds_read_b64_tr_b16 v[24:25], v11 offset:51200
    ds_read_b64_tr_b16 v[26:27], v11 offset:52224
    v_mfma_f32_32x32x16_bf16 v[112:127], v[44:47], a[28:31], v[112:127]
    s_waitcnt lgkmcnt(4)
    s_waitcnt vmcnt(8)
    v_mfma_f32_32x32x16_bf16 v[64:79], v[16:19], a[32:35], v[64:79]
    ds_read_b64_tr_b16 v[28:29], v12 offset:51200
    ds_read_b64_tr_b16 v[30:31], v12 offset:52224
    v_mfma_f32_32x32x16_bf16 v[80:95], v[16:19], a[48:51], v[80:95]
    s_waitcnt lgkmcnt(4)
    v_mfma_f32_32x32x16_bf16 v[96:111], v[20:23], a[32:35], v[96:111]
    s_lshl_b32 s64, s80, 16
    s_lshl_b32 s7, s81, 7
    s_add_u32 s64, s64, s7
    s_add_u32 s65, s64, 32768
    buffer_load_dwordx4 a[96:99], v49, s[8:11], s64 offen
    buffer_load_dwordx4 a[100:103], v49, s[8:11], s65 offen
    v_lshrrev_b32 v56, 3, v0
    v_lshlrev_b32 v56, 4, v56
    s_lshl_b32 s6, s80, 10
    s_add_u32 s6, s6, 65540
    buffer_load_dword v50, v56, s[12:15], s6 offen sc1
    buffer_load_dword v51, v56, s[12:15], s6 offen offset:512 sc1
    ds_read_b64_tr_b16 v[32:33], v11 offset:53248
    ds_read_b64_tr_b16 v[34:35], v11 offset:54272
    v_mfma_f32_32x32x16_bf16 v[112:127], v[20:23], a[48:51], v[112:127]
    s_waitcnt lgkmcnt(4)
    v_mfma_f32_32x32x16_bf16 v[64:79], v[24:27], a[36:39], v[64:79]
    ds_read_b64_tr_b16 v[36:37], v12 offset:53248
    ds_read_b64_tr_b16 v[38:39], v12 offset:54272
    v_mfma_f32_32x32x16_bf16 v[80:95], v[24:27], a[52:55], v[80:95]
    s_waitcnt lgkmcnt(4)
    v_mfma_f32_32x32x16_bf16 v[96:111], v[28:31], a[36:39], v[96:111]
    ds_read_b64_tr_b16 v[40:41], v11 offset:55296
    ds_read_b64_tr_b16 v[42:43], v11 offset:56320
    v_mfma_f32_32x32x16_bf16 v[112:127], v[28:31], a[52:55], v[112:127]
    s_waitcnt lgkmcnt(4)
    v_mfma_f32_32x32x16_bf16 v[64:79], v[32:35], a[40:43], v[64:79]
    ds_read_b64_tr_b16 v[44:45], v12 offset:55296
    ds_read_b64_tr_b16 v[46:47], v12 offset:56320
    v_mfma_f32_32x32x16_bf16 v[80:95], v[32:35], a[56:59], v[80:95]
    s_barrier
    s_waitcnt lgkmcnt(4)
    v_mfma_f32_32x32x16_bf16 v[96:111], v[36:39], a[40:43], v[96:111]
    ds_read_b64_tr_b16 v[16:17], v11 offset:16384
    ds_read_b64_tr_b16 v[18:19], v11 offset:17408
    v_mfma_f32_32x32x16_bf16 v[112:127], v[36:39], a[56:59], v[112:127]
    s_waitcnt lgkmcnt(4)
    v_mfma_f32_32x32x16_bf16 v[64:79], v[40:43], a[44:47], v[64:79]
    ds_read_b64_tr_b16 v[20:21], v12 offset:16384
    ds_read_b64_tr_b16 v[22:23], v12 offset:17408
    v_mfma_f32_32x32x16_bf16 v[80:95], v[40:43], a[60:63], v[80:95]
    s_waitcnt lgkmcnt(4)
    v_mfma_f32_32x32x16_bf16 v[96:111], v[44:47], a[44:47], v[96:111]
    ds_read_b64_tr_b16 v[24:25], v11 offset:18432
    ds_read_b64_tr_b16 v[26:27], v11 offset:19456
    v_mfma_f32_32x32x16_bf16 v[112:127], v[44:47], a[60:63], v[112:127]
    s_waitcnt lgkmcnt(4)
    s_waitcnt vmcnt(4)
    v_mfma_f32_32x32x16_bf16 v[64:79], v[16:19], a[64:67], v[64:79]
    ds_read_b64_tr_b16 v[28:29], v12 offset:18432
    ds_read_b64_tr_b16 v[30:31], v12 offset:19456
    v_mfma_f32_32x32x16_bf16 v[80:95], v[16:19], a[80:83], v[80:95]
    s_waitcnt lgkmcnt(4)
    v_mfma_f32_32x32x16_bf16 v[96:111], v[20:23], a[64:67], v[96:111]
    ds_read_b64_tr_b16 v[32:33], v11 offset:20480
    ds_read_b64_tr_b16 v[34:35], v11 offset:21504
    v_mfma_f32_32x32x16_bf16 v[112:127], v[20:23], a[80:83], v[112:127]
    s_waitcnt lgkmcnt(4)
    v_mfma_f32_32x32x16_bf16 v[64:79], v[24:27], a[68:71], v[64:79]
    ds_read_b64_tr_b16 v[36:37], v12 offset:20480
    ds_read_b64_tr_b16 v[38:39], v12 offset:21504
    v_mfma_f32_32x32x16_bf16 v[80:95], v[24:27], a[84:87], v[80:95]
    s_waitcnt lgkmcnt(4)
    v_mfma_f32_32x32x16_bf16 v[96:111], v[28:31], a[68:71], v[96:111]
    ds_read_b64_tr_b16 v[40:41], v11 offset:22528
    ds_read_b64_tr_b16 v[42:43], v11 offset:23552
    v_mfma_f32_32x32x16_bf16 v[112:127], v[28:31], a[84:87], v[112:127]
    s_waitcnt lgkmcnt(4)
    v_mfma_f32_32x32x16_bf16 v[64:79], v[32:35], a[72:75], v[64:79]
    ds_read_b64_tr_b16 v[44:45], v12 offset:22528
    ds_read_b64_tr_b16 v[46:47], v12 offset:23552
    v_mfma_f32_32x32x16_bf16 v[80:95], v[32:35], a[88:91], v[80:95]
    s_waitcnt lgkmcnt(4)
    v_mfma_f32_32x32x16_bf16 v[96:111], v[36:39], a[72:75], v[96:111]
    v_mfma_f32_32x32x16_bf16 v[112:127], v[36:39], a[88:91], v[112:127]
    s_waitcnt lgkmcnt(2)
    v_mfma_f32_32x32x16_bf16 v[64:79], v[40:43], a[76:79], v[64:79]
    v_mfma_f32_32x32x16_bf16 v[80:95], v[40:43], a[92:95], v[80:95]
    s_waitcnt lgkmcnt(0)
    v_mfma_f32_32x32x16_bf16 v[96:111], v[44:47], a[76:79], v[96:111]
    v_mfma_f32_32x32x16_bf16 v[112:127], v[44:47], a[92:95], v[112:127]
    v_and_b32 v56, 31, v1
    s_movk_i32 s7, 272
    v_mul_lo_u32 v56, v56, s7
    v_add_u32 v56, v56, v15
    s_mul_i32 s6, s46, 17408
    v_add_u32 v56, s6, v56
    s_nop 1
    ds_write_b128 v56, v[64:67] offset:0
    ds_write_b128 v56, v[68:71] offset:32
    ds_write_b128 v56, v[72:75] offset:64
    ds_write_b128 v56, v[76:79] offset:96
    ds_write_b128 v56, v[80:83] offset:8704
    ds_write_b128 v56, v[84:87] offset:8736
    ds_write_b128 v56, v[88:91] offset:8768
    ds_write_b128 v56, v[92:95] offset:8800
    ds_write_b128 v56, v[96:99] offset:128
    ds_write_b128 v56, v[100:103] offset:160
    ds_write_b128 v56, v[104:107] offset:192
    ds_write_b128 v56, v[108:111] offset:224
    ds_write_b128 v56, v[112:115] offset:8832
    ds_write_b128 v56, v[116:119] offset:8864
    ds_write_b128 v56, v[120:123] offset:8896
    ds_write_b128 v56, v[124:127] offset:8928
    v_lshrrev_b32 v57, 3, v0
    v_mul_lo_u32 v57, v57, s7
    v_and_b32 v58, 7, v0
    v_lshl_add_u32 v57, v58, 5, v57
    s_waitcnt lgkmcnt(0)
    s_barrier
    ds_read_b128 v[64:67], v57 offset:0
    ds_read_b128 v[68:71], v57 offset:16
    ds_read_b128 v[72:75], v57 offset:17408
    ds_read_b128 v[76:79], v57 offset:17424
    ds_read_b128 v[80:83], v57 offset:34816
    ds_read_b128 v[84:87], v57 offset:34832
    ds_read_b128 v[88:91], v57 offset:52224
    ds_read_b128 v[92:95], v57 offset:52240
    ds_read_b128 v[96:99], v57 offset:8704
    ds_read_b128 v[100:103], v57 offset:8720
    ds_read_b128 v[104:107], v57 offset:26112
    ds_read_b128 v[108:111], v57 offset:26128
    ds_read_b128 v[112:115], v57 offset:43520
    ds_read_b128 v[116:119], v57 offset:43536
    ds_read_b128 v[120:123], v57 offset:60928
    ds_read_b128 v[124:127], v57 offset:60944
    s_waitcnt vmcnt(0)
    v_accvgpr_read_b32 v16, a96
    v_accvgpr_read_b32 v17, a97
    v_accvgpr_read_b32 v18, a98
    v_accvgpr_read_b32 v19, a99
    v_accvgpr_read_b32 v20, a100
    v_accvgpr_read_b32 v21, a101
    v_accvgpr_read_b32 v22, a102
    v_accvgpr_read_b32 v23, a103
    s_waitcnt lgkmcnt(8)
    v_pk_add_f32 v[64:65], v[64:65], v[72:73]
    v_pk_add_f32 v[80:81], v[80:81], v[88:89]
    v_pk_add_f32 v[66:67], v[66:67], v[74:75]
    v_pk_add_f32 v[82:83], v[82:83], v[90:91]
    v_pk_add_f32 v[68:69], v[68:69], v[76:77]
    v_pk_add_f32 v[84:85], v[84:85], v[92:93]
    v_pk_add_f32 v[70:71], v[70:71], v[78:79]
    v_pk_add_f32 v[86:87], v[86:87], v[94:95]
    v_mul_f32 v58, v50, v50
    v_pk_add_f32 v[64:65], v[64:65], v[80:81]
    v_pk_add_f32 v[66:67], v[66:67], v[82:83]
    v_pk_add_f32 v[68:69], v[68:69], v[84:85]
    v_pk_add_f32 v[70:71], v[70:71], v[86:87]
    v_lshlrev_b32 v59, 16, v16
    v_and_b32 v60, 0xffff0000, v16
    v_fma_f32 v64, v64, v58, v59
    v_fma_f32 v65, v65, v58, v60
    v_lshlrev_b32 v59, 16, v17
    v_and_b32 v60, 0xffff0000, v17
    v_fma_f32 v66, v66, v58, v59
    v_fma_f32 v67, v67, v58, v60
    v_lshlrev_b32 v59, 16, v18
    v_and_b32 v60, 0xffff0000, v18
    v_fma_f32 v68, v68, v58, v59
    v_fma_f32 v69, v69, v58, v60
    v_lshlrev_b32 v59, 16, v19
    v_and_b32 v60, 0xffff0000, v19
    v_fma_f32 v70, v70, v58, v59
    v_fma_f32 v71, v71, v58, v60
    v_cvt_pk_bf16_f32 v24, v64, v65
    v_cvt_pk_bf16_f32 v25, v66, v67
    v_cvt_pk_bf16_f32 v26, v68, v69
    v_cvt_pk_bf16_f32 v27, v70, v71
    buffer_store_dwordx4 v[24:27], v49, s[16:19], s64 offen
    s_waitcnt lgkmcnt(0)
    v_pk_add_f32 v[96:97], v[96:97], v[104:105]
    v_pk_add_f32 v[112:113], v[112:113], v[120:121]
    v_pk_add_f32 v[98:99], v[98:99], v[106:107]
    v_pk_add_f32 v[114:115], v[114:115], v[122:123]
    v_pk_add_f32 v[100:101], v[100:101], v[108:109]
    v_pk_add_f32 v[116:117], v[116:117], v[124:125]
    v_pk_add_f32 v[102:103], v[102:103], v[110:111]
    v_pk_add_f32 v[118:119], v[118:119], v[126:127]
    v_mul_f32 v58, v51, v51
    v_pk_add_f32 v[96:97], v[96:97], v[112:113]
    v_pk_add_f32 v[98:99], v[98:99], v[114:115]
    v_pk_add_f32 v[100:101], v[100:101], v[116:117]
    v_pk_add_f32 v[102:103], v[102:103], v[118:119]
    v_lshlrev_b32 v59, 16, v20
    v_and_b32 v60, 0xffff0000, v20
    v_fma_f32 v96, v96, v58, v59
    v_fma_f32 v97, v97, v58, v60
    v_lshlrev_b32 v59, 16, v21
    v_and_b32 v60, 0xffff0000, v21
    v_fma_f32 v98, v98, v58, v59
    v_fma_f32 v99, v99, v58, v60
    v_lshlrev_b32 v59, 16, v22
    v_and_b32 v60, 0xffff0000, v22
    v_fma_f32 v100, v100, v58, v59
    v_fma_f32 v101, v101, v58, v60
    v_lshlrev_b32 v59, 16, v23
    v_and_b32 v60, 0xffff0000, v23
    v_fma_f32 v102, v102, v58, v59
    v_fma_f32 v103, v103, v58, v60
    v_cvt_pk_bf16_f32 v28, v96, v97
    v_cvt_pk_bf16_f32 v29, v98, v99
    v_cvt_pk_bf16_f32 v30, v100, v101
    v_cvt_pk_bf16_f32 v31, v102, v103
    buffer_store_dwordx4 v[28:31], v49, s[16:19], s65 offen
    s_endpgm
Lend:
    s_endpgm
Lslow_1:
    s_mov_b32 s66, 0x4000
Lspin_31:
    s_sleep 1
    buffer_load_dwordx4 v[48:51], v45, s[12:15], s72 offen sc1
    s_waitcnt vmcnt(0)
    v_cmp_eq_u32 vcc, v50, v30
    v_cmp_eq_u32 s[64:65], v51, v31
    s_nop 0
    s_and_b64 vcc, vcc, s[64:65]
    s_cmp_eq_u64 vcc, -1
    s_cbranch_scc1 Lback_2
    s_sub_u32 s66, s66, 1
    s_cmp_lg_u32 s66, 0
    s_cbranch_scc1 Lspin_31
    s_branch Lback_2
Lslow_3:
    s_mov_b32 s66, 0x4000
Lspin_32:
    s_sleep 1
    s_add_u32 s69, s68, 0
    buffer_load_dwordx2 v[52:53], v92, s[12:15], s69 offen sc1
    s_add_u32 s69, s68, 2048
    buffer_load_dwordx2 v[54:55], v92, s[12:15], s69 offen sc1
    s_add_u32 s69, s68, 4096
    buffer_load_dwordx2 v[56:57], v92, s[12:15], s69 offen sc1
    s_add_u32 s69, s68, 6144
    buffer_load_dwordx2 v[58:59], v92, s[12:15], s69 offen sc1
    s_add_u32 s69, s68, 8192
    buffer_load_dwordx2 v[60:61], v92, s[12:15], s69 offen sc1
    s_add_u32 s69, s68, 10240
    buffer_load_dwordx2 v[62:63], v92, s[12:15], s69 offen sc1
    s_add_u32 s69, s68, 12288
    buffer_load_dwordx2 v[64:65], v92, s[12:15], s69 offen sc1
    s_add_u32 s69, s68, 14336
    buffer_load_dwordx2 v[66:67], v92, s[12:15], s69 offen sc1
    s_waitcnt vmcnt(0)
    v_cmp_eq_u32 vcc, v53, v30
    v_cmp_eq_u32 s[64:65], v55, v30
    s_nop 0
    s_and_b64 vcc, vcc, s[64:65]
    v_cmp_eq_u32 s[64:65], v57, v30
    s_nop 0
    s_and_b64 vcc, vcc, s[64:65]
    v_cmp_eq_u32 s[64:65], v59, v30
    s_nop 0
    s_and_b64 vcc, vcc, s[64:65]
    v_cmp_eq_u32 s[64:65], v61, v30
    s_nop 0
    s_and_b64 vcc, vcc, s[64:65]
    v_cmp_eq_u32 s[64:65], v63, v30
    s_nop 0
    s_and_b64 vcc, vcc, s[64:65]
    v_cmp_eq_u32 s[64:65], v65, v30
    s_nop 0
    s_and_b64 vcc, vcc, s[64:65]
    v_cmp_eq_u32 s[64:65], v67, v30
    s_nop 0
    s_and_b64 vcc, vcc, s[64:65]
    s_cmp_eq_u64 vcc, -1
    s_cbranch_scc1 Lback_4
    s_sub_u32 s66, s66, 1
    s_cmp_lg_u32 s66, 0
    s_cbranch_scc1 Lspin_32
    s_branch Lback_4
Lslow_5:
    s_mov_b32 s66, 0x4000
Lspin_33:
    s_sleep 1
    s_add_u32 s69, s68, 0
    buffer_load_dwordx4 v[52:55], v92, s[12:15], s69 offen sc1
    s_add_u32 s69, s68, 4096
    buffer_load_dwordx4 v[56:59], v92, s[12:15], s69 offen sc1
    s_add_u32 s69, s68, 8192
    buffer_load_dwordx4 v[60:63], v92, s[12:15], s69 offen sc1
    s_add_u32 s69, s68, 12288
    buffer_load_dwordx4 v[64:67], v92, s[12:15], s69 offen sc1
    s_add_u32 s69, s68, 16384
    buffer_load_dwordx4 v[68:71], v92, s[12:15], s69 offen sc1
    s_add_u32 s69, s68, 20480
    buffer_load_dwordx4 v[72:75], v92, s[12:15], s69 offen sc1
    s_add_u32 s69, s68, 24576
    buffer_load_dwordx4 v[76:79], v92, s[12:15], s69 offen sc1
    s_add_u32 s69, s68, 28672
    buffer_load_dwordx4 v[80:83], v92, s[12:15], s69 offen sc1
    s_waitcnt vmcnt(0)
    v_cmp_eq_u32 vcc, v55, v30
    v_cmp_eq_u32 s[64:65], v59, v30
    s_nop 0
    s_and_b64 vcc, vcc, s[64:65]
    v_cmp_eq_u32 s[64:65], v63, v30
    s_nop 0
    s_and_b64 vcc, vcc, s[64:65]
    v_cmp_eq_u32 s[64:65], v67, v30
    s_nop 0
    s_and_b64 vcc, vcc, s[64:65]
    v_cmp_eq_u32 s[64:65], v71, v30
    s_nop 0
    s_and_b64 vcc, vcc, s[64:65]
    v_cmp_eq_u32 s[64:65], v75, v30
    s_nop 0
    s_and_b64 vcc, vcc, s[64:65]
    v_cmp_eq_u32 s[64:65], v79, v30
    s_nop 0
    s_and_b64 vcc, vcc, s[64:65]
    v_cmp_eq_u32 s[64:65], v83, v30
    s_nop 0
    s_and_b64 vcc, vcc, s[64:65]
    s_cmp_eq_u64 vcc, -1
    s_cbranch_scc1 Lback_6
    s_sub_u32 s66, s66, 1
    s_cmp_lg_u32 s66, 0
    s_cbranch_scc1 Lspin_33
    s_branch Lback_6
Lslow_7:
    s_mov_b32 s66, 0x4000
Lspin_34:
    s_sleep 1
    buffer_load_dwordx2 v[32:33], v27, s[12:15], s72 offen sc1
    s_waitcnt vmcnt(0)
    v_cmp_eq_u32 vcc, v32, v30
    v_cmp_eq_u32 s[64:65], v33, v31
    s_nop 0
    s_and_b64 vcc, vcc, s[64:65]
    s_cmp_eq_u64 vcc, -1
    s_cbranch_scc1 Lback_8
    s_sub_u32 s66, s66, 1
    s_cmp_lg_u32 s66, 0
    s_cbranch_scc1 Lspin_34
    s_branch Lback_8
Lslow_9:
    s_mov_b32 s66, 0x4000
Lspin_35:
    s_sleep 1
    buffer_load_dwordx2 v[32:33], v27, s[12:15], s72 offen sc1
    s_waitcnt vmcnt(0)
    v_cmp_eq_u32 vcc, v32, v30
    v_cmp_eq_u32 s[64:65], v33, v31
    s_nop 0
    s_and_b64 vcc, vcc, s[64:65]
    s_cmp_eq_u64 vcc, -1
    s_cbranch_scc1 Lback_10
    s_sub_u32 s66, s66, 1
    s_cmp_lg_u32 s66, 0
    s_cbranch_scc1 Lspin_35
    s_branch Lback_10
Lslow_11:
    s_mov_b32 s66, 0x4000
Lspin_36:
    s_sleep 1
    buffer_load_dwordx2 v[32:33], v27, s[12:15], s72 offen sc1
    s_waitcnt vmcnt(0)
    v_cmp_eq_u32 vcc, v32, v30
    v_cmp_eq_u32 s[64:65], v33, v31
    s_nop 0
    s_and_b64 vcc, vcc, s[64:65]
    s_cmp_eq_u64 vcc, -1
    s_cbranch_scc1 Lback_12
    s_sub_u32 s66, s66, 1
    s_cmp_lg_u32 s66, 0
    s_cbranch_scc1 Lspin_36
    s_branch Lback_12
Lslow_13:
    s_mov_b32 s66, 0x4000
Lspin_37:
    s_sleep 1
    buffer_load_dwordx4 v[48:51], v45, s[12:15], s72 offen sc1
    s_waitcnt vmcnt(0)
    v_cmp_eq_u32 vcc, v50, v30
    v_cmp_eq_u32 s[64:65], v51, v31
    s_nop 0
    s_and_b64 vcc, vcc, s[64:65]
    s_cmp_eq_u64 vcc, -1
    s_cbranch_scc1 Lback_14
    s_sub_u32 s66, s66, 1
    s_cmp_lg_u32 s66, 0
    s_cbranch_scc1 Lspin_37
    s_branch Lback_14
Lslow_15:
    s_mov_b32 s66, 0x4000
Lspin_38:
    s_sleep 1
    s_add_u32 s69, s68, 0
    buffer_load_dwordx2 v[52:53], v92, s[12:15], s69 offen sc1
    s_add_u32 s69, s68, 2048
    buffer_load_dwordx2 v[54:55], v92, s[12:15], s69 offen sc1
    s_add_u32 s69, s68, 4096
    buffer_load_dwordx2 v[56:57], v92, s[12:15], s69 offen sc1
    s_add_u32 s69, s68, 6144
    buffer_load_dwordx2 v[58:59], v92, s[12:15], s69 offen sc1
    s_add_u32 s69, s68, 8192
    buffer_load_dwordx2 v[60:61], v92, s[12:15], s69 offen sc1
    s_add_u32 s69, s68, 10240
    buffer_load_dwordx2 v[62:63], v92, s[12:15], s69 offen sc1
    s_add_u32 s69, s68, 12288
    buffer_load_dwordx2 v[64:65], v92, s[12:15], s69 offen sc1
    s_add_u32 s69, s68, 14336
    buffer_load_dwordx2 v[66:67], v92, s[12:15], s69 offen sc1
    s_waitcnt vmcnt(0)
    v_cmp_eq_u32 vcc, v53, v30
    v_cmp_eq_u32 s[64:65], v55, v30
    s_nop 0
    s_and_b64 vcc, vcc, s[64:65]
    v_cmp_eq_u32 s[64:65], v57, v30
    s_nop 0
    s_and_b64 vcc, vcc, s[64:65]
    v_cmp_eq_u32 s[64:65], v59, v30
    s_nop 0
    s_and_b64 vcc, vcc, s[64:65]
    v_cmp_eq_u32 s[64:65], v61, v30
    s_nop 0
    s_and_b64 vcc, vcc, s[64:65]
    v_cmp_eq_u32 s[64:65], v63, v30
    s_nop 0
    s_and_b64 vcc, vcc, s[64:65]
    v_cmp_eq_u32 s[64:65], v65, v30
    s_nop 0
    s_and_b64 vcc, vcc, s[64:65]
    v_cmp_eq_u32 s[64:65], v67, v30
    s_nop 0
    s_and_b64 vcc, vcc, s[64:65]
    s_cmp_eq_u64 vcc, -1
    s_cbranch_scc1 Lback_16
    s_sub_u32 s66, s66, 1
    s_cmp_lg_u32 s66, 0
    s_cbranch_scc1 Lspin_38
    s_branch Lback_16
Lslow_17:
    s_mov_b32 s66, 0x4000
Lspin_39:
    s_sleep 1
    s_add_u32 s69, s68, 0
    buffer_load_dwordx4 v[52:55], v92, s[12:15], s69 offen sc1
    s_add_u32 s69, s68, 4096
    buffer_load_dwordx4 v[56:59], v92, s[12:15], s69 offen sc1
    s_add_u32 s69, s68, 8192
    buffer_load_dwordx4 v[60:63], v92, s[12:15], s69 offen sc1
    s_add_u32 s69, s68, 12288
    buffer_load_dwordx4 v[64:67], v92, s[12:15], s69 offen sc1
    s_add_u32 s69, s68, 16384
    buffer_load_dwordx4 v[68:71], v92, s[12:15], s69 offen sc1
    s_add_u32 s69, s68, 20480
    buffer_load_dwordx4 v[72:75], v92, s[12:15], s69 offen sc1
    s_add_u32 s69, s68, 24576
    buffer_load_dwordx4 v[76:79], v92, s[12:15], s69 offen sc1
    s_add_u32 s69, s68, 28672
    buffer_load_dwordx4 v[80:83], v92, s[12:15], s69 offen sc1
    s_waitcnt vmcnt(0)
    v_cmp_eq_u32 vcc, v55, v30
    v_cmp_eq_u32 s[64:65], v59, v30
    s_nop 0
    s_and_b64 vcc, vcc, s[64:65]
    v_cmp_eq_u32 s[64:65], v63, v30
    s_nop 0
    s_and_b64 vcc, vcc, s[64:65]
    v_cmp_eq_u32 s[64:65], v67, v30
    s_nop 0
    s_and_b64 vcc, vcc, s[64:65]
    v_cmp_eq_u32 s[64:65], v71, v30
    s_nop 0
    s_and_b64 vcc, vcc, s[64:65]
    v_cmp_eq_u32 s[64:65], v75, v30
    s_nop 0
    s_and_b64 vcc, vcc, s[64:65]
    v_cmp_eq_u32 s[64:65], v79, v30
    s_nop 0
    s_and_b64 vcc, vcc, s[64:65]
    v_cmp_eq_u32 s[64:65], v83, v30
    s_nop 0
    s_and_b64 vcc, vcc, s[64:65]
    s_cmp_eq_u64 vcc, -1
    s_cbranch_scc1 Lback_18
    s_sub_u32 s66, s66, 1
    s_cmp_lg_u32 s66, 0
    s_cbranch_scc1 Lspin_39
    s_branch Lback_18
Lslow_19:
    s_mov_b32 s66, 0x4000
Lspin_40:
    s_sleep 1
    buffer_load_dwordx2 v[42:43], v40, s[12:15], s71 offen sc1
    s_waitcnt vmcnt(0)
    v_cmp_eq_u32 vcc, v42, v30
    v_cmp_eq_u32 s[64:65], v43, v31
    s_nop 0
    s_and_b64 vcc, vcc, s[64:65]
    s_cmp_eq_u64 vcc, -1
    s_cbranch_scc1 Lback_20
    s_sub_u32 s66, s66, 1
    s_cmp_lg_u32 s66, 0
    s_cbranch_scc1 Lspin_40
    s_branch Lback_20
Lslow_21:
    s_mov_b32 s66, 0x4000
Lspin_41:
    s_sleep 1
    buffer_load_dwordx2 v[32:33], v27, s[12:15], s72 offen sc1
    s_waitcnt vmcnt(0)
    v_cmp_eq_u32 vcc, v32, v30
    v_cmp_eq_u32 s[64:65], v33, v31
    s_nop 0
    s_and_b64 vcc, vcc, s[64:65]
    s_cmp_eq_u64 vcc, -1
    s_cbranch_scc1 Lback_22
    s_sub_u32 s66, s66, 1
    s_cmp_lg_u32 s66, 0
    s_cbranch_scc1 Lspin_41
    s_branch Lback_22
Lslow_23:
    s_mov_b32 s66, 0x4000
Lspin_42:
    s_sleep 1
    buffer_load_dwordx2 v[32:33], v27, s[12:15], s72 offen sc1
    s_waitcnt vmcnt(0)
    v_cmp_eq_u32 vcc, v32, v30
    v_cmp_eq_u32 s[64:65], v33, v31
    s_nop 0
    s_and_b64 vcc, vcc, s[64:65]
    s_cmp_eq_u64 vcc, -1
    s_cbranch_scc1 Lback_24
    s_sub_u32 s66, s66, 1
    s_cmp_lg_u32 s66, 0
    s_cbranch_scc1 Lspin_42
    s_branch Lback_24
Lslow_25:
    s_mov_b32 s66, 0x4000
Lspin_43:
    s_sleep 1
    buffer_load_dwordx2 v[32:33], v27, s[12:15], s72 offen sc1
    s_waitcnt vmcnt(0)
    v_cmp_eq_u32 vcc, v32, v30
    v_cmp_eq_u32 s[64:65], v33, v31
    s_nop 0
    s_and_b64 vcc, vcc, s[64:65]
    s_cmp_eq_u64 vcc, -1
    s_cbranch_scc1 Lback_26
    s_sub_u32 s66, s66, 1
    s_cmp_lg_u32 s66, 0
    s_cbranch_scc1 Lspin_43
    s_branch Lback_26
Lcode_end:

.section .rodata,"a"
.p2align 6
.amdhsa_kernel parallel_sum__linear_attn_block__glu_gated_reglu__prompt_kernel
  .amdhsa_next_free_vgpr 256
  .amdhsa_next_free_sgpr 102
  .amdhsa_accum_offset 128
  .amdhsa_group_segment_fixed_size 0
  .amdhsa_kernarg_size 80
  .amdhsa_user_sgpr_count 2
  .amdhsa_user_sgpr_kernarg_segment_ptr 1
  .amdhsa_system_sgpr_workgroup_id_x 1
.end_amdhsa_kernel
```
